```python
import torch

def _softmax(x, axis=-1):
    return torch.softmax(x, dim=axis)
def _gelu(x):
    return torch.nn.functional.gelu(x, approximate="tanh")
def _silu(x):
    return torch.nn.functional.silu(x)
def _sigmoid(x):
    return torch.sigmoid(x)
def _layernorm(x, axis=-1, eps=1e-5):
    m = x.mean(dim=axis, keepdim=True)
    v = x.var(dim=axis, keepdim=True, unbiased=False)
    return (x - m) / torch.sqrt(v + eps)
def _scatter_add(tgt, idx, src, axis=0):
    return tgt.clone().index_add_(axis, idx, src)
def _segment_sum(src, seg, n):
    out = torch.zeros((n,) + src.shape[1:], dtype=src.dtype)
    return out.index_add_(0, seg, src)
def _pad(x, pw):
    flat = tuple(v for pair in reversed(pw) for v in pair)
    return torch.nn.functional.pad(x, flat)

kernel_name = 'parallel_sum__sliding_block_cached__swiglu_ffn__decode'

def setup_inputs():

    _w = (lambda a: (lambda t: t.to(torch.bfloat16) if t.is_floating_point() else t)(torch.as_tensor(a)))
    def _A_setup():
        B, Sq, D = 4, 1, 448
        Hq, Hkv, Sk, Dh = 16, 8, 16384, 256
        assert Hq % Hkv == 0, (Hq, Hkv)
        return {
            "x": _w((lambda *s: torch.randn(*s, dtype=torch.bfloat16) * 0.05)(B, Sq, D)),
            "k_cache": _w((lambda *s: torch.randn(*s, dtype=torch.bfloat16) * 3.2)(B, Hkv, Sk, Dh)),
            "v_cache": _w((lambda *s: torch.randn(*s, dtype=torch.bfloat16) * 1.6)(B, Hkv, Sk, Dh)),
            "wq": _w((lambda *s: torch.randn(*s, dtype=torch.bfloat16) * 3.2)(D, Hq * Dh) * (D ** -0.5)),
            "wo": _w((lambda *s: torch.randn(*s, dtype=torch.bfloat16) * 1.6)(Hq * Dh, D) * ((Hq * Dh) ** -0.5)),
        }
    _A_in = _A_setup()

    def _B_setup():
        B, S, D, F = 4, 1, 448, 1792
        return {
            "x": _w((lambda *s: torch.randn(*s, dtype=torch.bfloat16) * 0.05)(B, S, D)),
            "w_gate": _w((lambda *s: torch.randn(*s, dtype=torch.bfloat16) * 0.05)(D, F)),
            "w_up": _w((lambda *s: torch.randn(*s, dtype=torch.bfloat16) * 0.05)(D, F)),
            "w_down": _w((lambda *s: torch.randn(*s, dtype=torch.bfloat16) * 0.05)(F, D)),
        }
    _B_in = _B_setup()

    return {
        "A_x": _A_in["x"],
        "A_k_cache": _A_in["k_cache"],
        "A_v_cache": _A_in["v_cache"],
        "A_wq": _A_in["wq"],
        "A_wo": _A_in["wo"],
        "B_x": _B_in["x"],
        "B_w_gate": _B_in["w_gate"],
        "B_w_up": _B_in["w_up"],
        "B_w_down": _B_in["w_down"],
    }

def reference(A_x, A_k_cache, A_v_cache, A_wq, A_wo, B_x, B_w_gate, B_w_up, B_w_down):
    def _A_ref(x, k_cache, v_cache, wq, wo):
        B, Sq, D = x.shape
        Hq, Dh = 16, 256
        Hkv, Sk = k_cache.shape[1], k_cache.shape[2]
        W = min(4096, max(256, Sk // 4))
        rep = Hq // Hkv
        q = (lambda x, *d: x.permute(*d))((x @ wq).reshape(B, Sq, Hq, Dh), 0, 2, 1, 3)
        k = (lambda x, n, axis: torch.repeat_interleave(x, n, dim=axis))(k_cache[:, :, Sk - W:, :], rep, axis=1)
        v = (lambda x, n, axis: torch.repeat_interleave(x, n, dim=axis))(v_cache[:, :, Sk - W:, :], rep, axis=1)
        scores = torch.einsum("bhqd,bhkd->bhqk", q, k) * (Dh ** -0.5)
        p = _softmax(scores, axis=-1)
        o = torch.einsum("bhqk,bhkd->bhqd", p, v)
        return (lambda x, *d: x.permute(*d))(o, 0, 2, 1, 3).reshape(B, Sq, Hq * Dh) @ wo

    def _B_ref(x, w_gate, w_up, w_down):
        g = _silu(x @ w_gate)
        u = x @ w_up
        return (g * u) @ w_down

    x = A_x
    xn = _layernorm(x, axis=-1)
    return x + _A_ref(xn, A_k_cache, A_v_cache, A_wq, A_wo) + _B_ref(xn, B_w_gate, B_w_up, B_w_down)
```

```asm
; @launch grid=(256,1,1) block=(512,1,1) lds=49408
.amdgcn_target "amdgcn-amd-amdhsa--gfx950"
.text
.globl parallel_sum__sliding_block_cached__swiglu_ffn__decode_kernel
.p2align 8
.type parallel_sum__sliding_block_cached__swiglu_ffn__decode_kernel,@function
parallel_sum__sliding_block_cached__swiglu_ffn__decode_kernel:
    s_cmp_ge_u32 s2, 256
    s_cbranch_scc1 L_end
    s_load_dwordx16 s[64:79], s[0:1], 0
    s_load_dwordx8 s[80:87], s[0:1], 64
    s_getpc_b64 s[98:99]
    v_lshlrev_b32 v42, 6, v0
    v_min_u32 v42, L_end-parallel_sum__sliding_block_cached__swiglu_ffn__decode_kernel-64, v42
    global_load_dword v43, v42, s[98:99]
    v_and_b32 v1, 63, v0
    v_lshrrev_b32 v3, 6, v0
    s_nop 0
    v_readfirstlane_b32 s52, v3
    v_lshlrev_b32 v2, 4, v0
    s_lshr_b32 s3, s2, 3
    s_and_b32 s4, s2, 7
    s_lshl_b32 s5, s3, 23
    s_xor_b32 s6, s4, 0
    s_lshl_b32 s6, s6, 18
    s_add_u32 s5, s5, s6
    s_add_u32 s5, s5, 6291456
    s_lshr_b32 s53, s2, 6
    s_and_b32 s55, s2, 63
    s_mul_i32 s6, s53, 917504
    s_lshl_b32 s7, s55, 7
    s_add_u32 s6, s6, s7
    s_sub_u32 s7, 917504, s7
    s_cmp_ge_u32 s55, 28
    s_cselect_b32 s56, 28, 0
    s_cselect_b32 s57, 4, 0
    s_sub_u32 s56, s55, s56
    s_mul_i32 s58, s53, 401408
    s_lshl_b32 s59, s56, 7
    s_add_u32 s58, s58, s59
    s_sub_u32 s59, 401408, s59
    s_cmp_ge_u32 s55, 56
    s_cselect_b32 s59, 0, s59
    v_mul_u32_u24 v4, 896, v3
    v_lshl_add_u32 v4, v1, 4, v4
    v_lshrrev_b32 v16, 3, v1
    v_and_b32 v19, 7, v1
    v_lshl_add_u32 v6, v3, 4, v16
    v_lshlrev_b32 v22, 13, v6
    v_lshl_add_u32 v22, v19, 4, v22
    v_mul_u32_u24 v17, 3584, v6
    v_lshl_add_u32 v17, v19, 4, v17
    s_mov_b32 s54, 0x10000
    s_mov_b32 s61, 28672
    s_mov_b32 s60, 0
    s_cmp_ge_u32 s55, 28
    s_waitcnt lgkmcnt(0)
    s_cselect_b32 s76, s78, s76
    s_cselect_b32 s77, s79, s77
    s_load_dword s101, s[86:87], 269824
    s_mov_b32 s36, s64
    s_mov_b32 s37, s65
    s_mov_b32 s38, 3584
    s_mov_b32 s39, 0x20000
    s_add_u32 s24, s76, s58
    s_addc_u32 s25, s77, 0
    s_mov_b32 s26, s59
    s_mov_b32 s27, 0x20000
    s_add_u32 s16, s70, s6
    s_addc_u32 s17, s71, 0
    s_mov_b32 s18, s7
    s_mov_b32 s19, 0x20000
    s_add_u32 s8, s66, s5
    s_addc_u32 s9, s67, 0
    s_mov_b32 s10, 262144
    s_mov_b32 s11, 0x20000
    s_mov_b32 s48, s86
    s_mov_b32 s49, s87
    s_mov_b32 s50, 4194304
    s_mov_b32 s51, 0x20000
    buffer_load_dwordx4 v[96:99], v4, s[36:39], 0 offen
    buffer_load_dwordx4 v[52:55], v22, s[16:19], 0 offen nt
    buffer_load_dwordx4 v[56:59], v22, s[16:19], s54 offen nt
    buffer_load_dwordx4 v[44:47], v17, s[24:27], 0 offen nt
    buffer_load_dwordx4 v[48:51], v17, s[24:27], s61 offen nt
    s_lshl_b32 s62, s2, 12
    s_add_u32 s62, s62, 1048576
    s_lshl_b32 s63, s2, 11
    s_add_u32 s63, s63, 524288
    v_mov_b32 v60, -1
    v_lshlrev_b32 v61, 2, v1
    ds_write_b32 v61, v60 offset:9216
    s_barrier
    buffer_load_dwordx4 v[128:131], v2, s[8:11], s60 offen nt
    s_add_u32 s60, s60, 0x2000
    buffer_load_dwordx4 v[132:135], v2, s[8:11], s60 offen nt
    s_add_u32 s60, s60, 0x2000
    buffer_load_dwordx4 v[136:139], v2, s[8:11], s60 offen nt
    s_add_u32 s60, s60, 0x2000
    buffer_load_dwordx4 v[140:143], v2, s[8:11], s60 offen nt
    s_add_u32 s60, s60, 0x2000
    buffer_load_dwordx4 v[144:147], v2, s[8:11], s60 offen nt
    s_add_u32 s60, s60, 0x2000
    s_add_u32 s12, s68, s5
    s_addc_u32 s13, s69, 0
    s_mov_b32 s14, 262144
    s_mov_b32 s15, 0x20000
    s_mov_b32 s40, s82
    s_mov_b32 s41, s83
    s_mov_b32 s42, 3584
    s_mov_b32 s43, 0x20000
    s_mul_i32 s5, s55, 25088
    s_add_u32 s32, s80, s5
    s_addc_u32 s33, s81, 0
    s_mov_b32 s34, 25088
    s_mov_b32 s35, 0x20000
    s_mul_i32 s5, s55, 57344
    s_add_u32 s20, s72, s5
    s_addc_u32 s21, s73, 0
    s_mov_b32 s22, 57344
    s_mov_b32 s23, 0x20000
    s_lshl_b32 s6, s53, 16
    s_lshl_b32 s5, s55, 8
    s_add_u32 s6, s6, s5
    s_add_u32 s7, s57, s53
    s_lshl_b32 s7, s7, 15
    s_lshl_b32 s5, s56, 8
    s_add_u32 s7, s7, s5
    s_add_u32 s7, s7, 262144
    s_mov_b32 s56, 0xcccccccc
    s_mov_b32 s57, s56
    s_mov_b32 s58, 0xaaaaaaaa
    s_mov_b32 s59, s58
    s_mov_b32 s64, 0x05040100
    s_mov_b32 s65, 0x07060302
    s_mov_b32 s66, 0x3db8aa3b
    s_getreg_b32 s96, hwreg(HW_REG_XCC_ID)
    s_and_b32 s96, s96, 1
    s_mul_i32 s5, s53, 224
    v_lshl_add_u32 v6, v6, 1, s5
    v_lshrrev_b32 v23, 5, v1
    v_and_b32 v5, 31, v1
    v_bfrev_b32 v5, v5
    v_lshrrev_b32 v5, 27, v5
    v_lshrrev_b32 v20, 4, v1
    v_lshlrev_b32 v21, 8, v20
    v_lshl_add_u32 v21, v19, 5, v21
    v_and_b32 v18, 8, v1
    v_lshl_add_u32 v21, v18, 1, v21
    v_lshl_add_u32 v21, v3, 10, v21
    s_cmp_ge_u32 s52, 4
    s_cbranch_scc1 L_noln
    v_mov_b32 v60, 0
    v_mov_b32 v62, 0
    s_mov_b32 exec_hi, 0x00ffffff
    s_waitcnt vmcnt(9)
    v_lshlrev_b32 v24, 16, v96
    v_and_b32 v25, 0xffff0000, v96
    v_lshlrev_b32 v26, 16, v97
    v_and_b32 v27, 0xffff0000, v97
    v_lshlrev_b32 v28, 16, v98
    v_and_b32 v29, 0xffff0000, v98
    v_lshlrev_b32 v30, 16, v99
    v_and_b32 v31, 0xffff0000, v99
    v_pk_add_f32 v[32:33], v[24:25], v[26:27]
    v_pk_add_f32 v[34:35], v[28:29], v[30:31]
    v_pk_add_f32 v[32:33], v[32:33], v[34:35]
    v_add_f32 v60, v32, v33
    s_mov_b32 exec_hi, -1
    v_mov_b32 v61, v60
    s_nop 1
    v_permlane32_swap_b32 v60, v61
    v_add_f32 v60, v60, v61
    s_nop 1
    v_add_f32_dpp v60, v60, v60 row_ror:8 row_mask:0xf bank_mask:0xf
    s_nop 1
    v_add_f32_dpp v60, v60, v60 row_ror:4 row_mask:0xf bank_mask:0xf
    s_nop 1
    v_add_f32_dpp v60, v60, v60 row_ror:2 row_mask:0xf bank_mask:0xf
    s_nop 1
    v_add_f32_dpp v60, v60, v60 row_ror:1 row_mask:0xf bank_mask:0xf
    v_mov_b32 v61, v60
    s_nop 1
    v_permlane16_swap_b32 v60, v61
    v_add_f32 v60, v60, v61
    v_mul_f32 v60, 0xbb124925, v60
    v_mov_b32 v61, v60
    s_mov_b32 exec_hi, 0x00ffffff
    v_pk_add_f32 v[32:33], v[24:25], v[60:61]
    v_pk_add_f32 v[34:35], v[26:27], v[60:61]
    v_pk_add_f32 v[36:37], v[28:29], v[60:61]
    v_pk_add_f32 v[38:39], v[30:31], v[60:61]
    v_pk_mul_f32 v[32:33], v[32:33], v[32:33]
    v_pk_mul_f32 v[34:35], v[34:35], v[34:35]
    v_pk_fma_f32 v[32:33], v[36:37], v[36:37], v[32:33]
    v_pk_fma_f32 v[34:35], v[38:39], v[38:39], v[34:35]
    v_pk_add_f32 v[32:33], v[32:33], v[34:35]
    v_add_f32 v62, v32, v33
    s_mov_b32 exec_hi, -1
    v_mov_b32 v63, v62
    s_nop 1
    v_permlane32_swap_b32 v62, v63
    v_add_f32 v62, v62, v63
    s_nop 1
    v_add_f32_dpp v62, v62, v62 row_ror:8 row_mask:0xf bank_mask:0xf
    s_nop 1
    v_add_f32_dpp v62, v62, v62 row_ror:4 row_mask:0xf bank_mask:0xf
    s_nop 1
    v_add_f32_dpp v62, v62, v62 row_ror:2 row_mask:0xf bank_mask:0xf
    s_nop 1
    v_add_f32_dpp v62, v62, v62 row_ror:1 row_mask:0xf bank_mask:0xf
    v_mov_b32 v63, v62
    s_nop 1
    v_permlane16_swap_b32 v62, v63
    v_add_f32 v62, v62, v63
    v_mul_f32 v62, 0x3b124925, v62
    v_cvt_pk_bf16_f32 v62, v62, v62
    v_and_b32 v62, 0xffff0000, v62
    v_cvt_pk_bf16_f32 v60, v60, v60
    v_and_b32 v60, 0xffff0000, v60
    v_add_f32 v62, 0x3727c5ac, v62
    v_cvt_pk_bf16_f32 v62, v62, v62
    v_and_b32 v62, 0xffff0000, v62
    v_sqrt_f32 v62, v62
    s_nop 0
    v_cvt_pk_bf16_f32 v62, v62, v62
    v_and_b32 v62, 0xffff0000, v62
    v_rcp_f32 v63, v62
    v_add_f32 v24, v60, v24
    v_add_f32 v25, v60, v25
    v_add_f32 v26, v60, v26
    v_add_f32 v27, v60, v27
    v_add_f32 v28, v60, v28
    v_add_f32 v29, v60, v29
    v_add_f32 v30, v60, v30
    v_add_f32 v31, v60, v31
    v_cvt_pk_bf16_f32 v96, v24, v25
    v_cvt_pk_bf16_f32 v97, v26, v27
    v_cvt_pk_bf16_f32 v98, v28, v29
    v_cvt_pk_bf16_f32 v99, v30, v31
    v_lshlrev_b32 v24, 16, v96
    v_and_b32 v25, 0xffff0000, v96
    v_lshlrev_b32 v26, 16, v97
    v_and_b32 v27, 0xffff0000, v97
    v_lshlrev_b32 v28, 16, v98
    v_and_b32 v29, 0xffff0000, v98
    v_lshlrev_b32 v30, 16, v99
    v_and_b32 v31, 0xffff0000, v99
    v_mul_f32 v32, v63, v24
    v_mul_f32 v33, v63, v25
    v_mul_f32 v34, v63, v26
    v_mul_f32 v35, v63, v27
    v_mul_f32 v36, v63, v28
    v_mul_f32 v37, v63, v29
    v_mul_f32 v38, v63, v30
    v_mul_f32 v39, v63, v31
    v_fma_f32 v24, -v32, v62, v24
    v_fma_f32 v25, -v33, v62, v25
    v_fma_f32 v26, -v34, v62, v26
    v_fma_f32 v27, -v35, v62, v27
    v_fma_f32 v28, -v36, v62, v28
    v_fma_f32 v29, -v37, v62, v29
    v_fma_f32 v30, -v38, v62, v30
    v_fma_f32 v31, -v39, v62, v31
    v_fmac_f32 v32, v24, v63
    v_fmac_f32 v33, v25, v63
    v_fmac_f32 v34, v26, v63
    v_fmac_f32 v35, v27, v63
    v_fmac_f32 v36, v28, v63
    v_fmac_f32 v37, v29, v63
    v_fmac_f32 v38, v30, v63
    v_fmac_f32 v39, v31, v63
    v_cvt_pk_bf16_f32 v96, v32, v33
    v_cvt_pk_bf16_f32 v97, v34, v35
    v_cvt_pk_bf16_f32 v98, v36, v37
    v_cvt_pk_bf16_f32 v99, v38, v39
    s_mov_b32 exec_hi, 0x00ffffff
    ds_write_b128 v4, v[96:99] offset:0
    s_mov_b32 exec_hi, -1
    s_waitcnt lgkmcnt(0)
L_noln:
    s_nop 4
    s_barrier
    ds_read_u16 v104, v6 offset:0
    ds_read_u16 v108, v6 offset:16
    ds_read_u16 v105, v6 offset:896
    ds_read_u16 v109, v6 offset:912
    ds_read_u16 v106, v6 offset:1792
    ds_read_u16 v110, v6 offset:1808
    ds_read_u16 v107, v6 offset:2688
    ds_read_u16 v111, v6 offset:2704
    s_waitcnt vmcnt(5)
    s_waitcnt lgkmcnt(0)
    v_lshl_or_b32 v104, v108, 16, v104
    v_lshl_or_b32 v105, v109, 16, v105
    v_lshl_or_b32 v106, v110, 16, v106
    v_lshl_or_b32 v107, v111, 16, v107
    v_perm_b32 v96, v56, v52, s64
    v_perm_b32 v97, v56, v52, s65
    v_perm_b32 v98, v57, v53, s64
    v_perm_b32 v99, v57, v53, s65
    v_perm_b32 v100, v58, v54, s64
    v_perm_b32 v101, v58, v54, s65
    v_perm_b32 v102, v59, v55, s64
    v_perm_b32 v103, v59, v55, s65
    v_dot2_f32_bf16 v64, v96, v104, 0
    v_dot2_f32_bf16 v65, v97, v104, 0
    v_dot2_f32_bf16 v66, v98, v104, 0
    v_dot2_f32_bf16 v67, v99, v104, 0
    v_dot2_f32_bf16 v68, v100, v104, 0
    v_dot2_f32_bf16 v69, v101, v104, 0
    v_dot2_f32_bf16 v70, v102, v104, 0
    v_dot2_f32_bf16 v71, v103, v104, 0
    v_dot2_f32_bf16 v80, v96, v106, 0
    v_dot2_f32_bf16 v81, v97, v106, 0
    v_dot2_f32_bf16 v82, v98, v106, 0
    v_dot2_f32_bf16 v83, v99, v106, 0
    v_dot2_f32_bf16 v84, v100, v106, 0
    v_dot2_f32_bf16 v85, v101, v106, 0
    v_dot2_f32_bf16 v86, v102, v106, 0
    v_dot2_f32_bf16 v87, v103, v106, 0
    v_dot2_f32_bf16 v72, v96, v105, 0
    v_dot2_f32_bf16 v73, v97, v105, 0
    v_dot2_f32_bf16 v74, v98, v105, 0
    v_dot2_f32_bf16 v75, v99, v105, 0
    v_dot2_f32_bf16 v76, v100, v105, 0
    v_dot2_f32_bf16 v77, v101, v105, 0
    v_dot2_f32_bf16 v78, v102, v105, 0
    v_dot2_f32_bf16 v79, v103, v105, 0
    v_dot2_f32_bf16 v88, v96, v107, 0
    v_dot2_f32_bf16 v89, v97, v107, 0
    v_dot2_f32_bf16 v90, v98, v107, 0
    v_dot2_f32_bf16 v91, v99, v107, 0
    v_dot2_f32_bf16 v92, v100, v107, 0
    v_dot2_f32_bf16 v93, v101, v107, 0
    v_dot2_f32_bf16 v94, v102, v107, 0
    v_dot2_f32_bf16 v95, v103, v107, 0
    v_permlane32_swap_b32 v64, v80
    v_permlane32_swap_b32 v65, v81
    v_permlane32_swap_b32 v66, v82
    v_permlane32_swap_b32 v67, v83
    v_permlane32_swap_b32 v68, v84
    v_permlane32_swap_b32 v69, v85
    buffer_load_dwordx4 v[148:151], v2, s[8:11], s60 offen nt
    s_add_u32 s60, s60, 0x2000
    v_permlane32_swap_b32 v70, v86
    v_permlane32_swap_b32 v71, v87
    v_permlane32_swap_b32 v72, v88
    v_permlane32_swap_b32 v73, v89
    v_permlane32_swap_b32 v74, v90
    v_permlane32_swap_b32 v75, v91
    v_permlane32_swap_b32 v76, v92
    v_permlane32_swap_b32 v77, v93
    v_permlane32_swap_b32 v78, v94
    v_permlane32_swap_b32 v79, v95
    v_pk_add_f32 v[64:65], v[64:65], v[80:81]
    v_pk_add_f32 v[66:67], v[66:67], v[82:83]
    v_pk_add_f32 v[68:69], v[68:69], v[84:85]
    v_pk_add_f32 v[70:71], v[70:71], v[86:87]
    v_pk_add_f32 v[72:73], v[72:73], v[88:89]
    v_pk_add_f32 v[74:75], v[74:75], v[90:91]
    v_pk_add_f32 v[76:77], v[76:77], v[92:93]
    v_pk_add_f32 v[78:79], v[78:79], v[94:95]
    v_permlane16_swap_b32 v64, v72
    v_permlane16_swap_b32 v65, v73
    v_permlane16_swap_b32 v66, v74
    v_permlane16_swap_b32 v67, v75
    v_permlane16_swap_b32 v68, v76
    v_permlane16_swap_b32 v69, v77
    v_permlane16_swap_b32 v70, v78
    v_permlane16_swap_b32 v71, v79
    v_pk_add_f32 v[64:65], v[64:65], v[72:73]
    v_pk_add_f32 v[66:67], v[66:67], v[74:75]
    v_pk_add_f32 v[68:69], v[68:69], v[76:77]
    v_pk_add_f32 v[70:71], v[70:71], v[78:79]
    v_add_f32_dpp v112, v64, v64 row_ror:8 row_mask:0xf bank_mask:0x3
    v_add_f32_dpp v113, v65, v65 row_ror:8 row_mask:0xf bank_mask:0x3
    v_add_f32_dpp v114, v66, v66 row_ror:8 row_mask:0xf bank_mask:0x3
    v_add_f32_dpp v115, v67, v67 row_ror:8 row_mask:0xf bank_mask:0x3
    v_add_f32_dpp v112, v68, v68 row_ror:8 row_mask:0xf bank_mask:0xc
    v_add_f32_dpp v113, v69, v69 row_ror:8 row_mask:0xf bank_mask:0xc
    v_add_f32_dpp v114, v70, v70 row_ror:8 row_mask:0xf bank_mask:0xc
    v_add_f32_dpp v115, v71, v71 row_ror:8 row_mask:0xf bank_mask:0xc
    ds_write_b128 v21, v[112:115] offset:12288
    v_perm_b32 v96, v48, v44, s64
    v_perm_b32 v97, v48, v44, s65
    v_perm_b32 v98, v49, v45, s64
    v_perm_b32 v99, v49, v45, s65
    v_perm_b32 v100, v50, v46, s64
    v_perm_b32 v101, v50, v46, s65
    v_perm_b32 v102, v51, v47, s64
    v_perm_b32 v103, v51, v47, s65
    v_dot2_f32_bf16 v64, v96, v104, 0
    v_dot2_f32_bf16 v65, v97, v104, 0
    v_dot2_f32_bf16 v66, v98, v104, 0
    v_dot2_f32_bf16 v67, v99, v104, 0
    buffer_load_dwordx4 v[152:155], v2, s[8:11], s60 offen nt
    s_add_u32 s60, s60, 0x2000
    v_dot2_f32_bf16 v68, v100, v104, 0
    v_dot2_f32_bf16 v69, v101, v104, 0
    v_dot2_f32_bf16 v70, v102, v104, 0
    v_dot2_f32_bf16 v71, v103, v104, 0
    v_dot2_f32_bf16 v80, v96, v106, 0
    v_dot2_f32_bf16 v81, v97, v106, 0
    v_dot2_f32_bf16 v82, v98, v106, 0
    v_dot2_f32_bf16 v83, v99, v106, 0
    v_dot2_f32_bf16 v84, v100, v106, 0
    v_dot2_f32_bf16 v85, v101, v106, 0
    v_dot2_f32_bf16 v86, v102, v106, 0
    v_dot2_f32_bf16 v87, v103, v106, 0
    v_dot2_f32_bf16 v72, v96, v105, 0
    v_dot2_f32_bf16 v73, v97, v105, 0
    v_dot2_f32_bf16 v74, v98, v105, 0
    v_dot2_f32_bf16 v75, v99, v105, 0
    v_dot2_f32_bf16 v76, v100, v105, 0
    v_dot2_f32_bf16 v77, v101, v105, 0
    v_dot2_f32_bf16 v78, v102, v105, 0
    v_dot2_f32_bf16 v79, v103, v105, 0
    v_dot2_f32_bf16 v88, v96, v107, 0
    v_dot2_f32_bf16 v89, v97, v107, 0
    v_dot2_f32_bf16 v90, v98, v107, 0
    v_dot2_f32_bf16 v91, v99, v107, 0
    v_dot2_f32_bf16 v92, v100, v107, 0
    v_dot2_f32_bf16 v93, v101, v107, 0
    v_dot2_f32_bf16 v94, v102, v107, 0
    v_dot2_f32_bf16 v95, v103, v107, 0
    v_permlane32_swap_b32 v64, v80
    v_permlane32_swap_b32 v65, v81
    v_permlane32_swap_b32 v66, v82
    v_permlane32_swap_b32 v67, v83
    v_permlane32_swap_b32 v68, v84
    v_permlane32_swap_b32 v69, v85
    v_permlane32_swap_b32 v70, v86
    v_permlane32_swap_b32 v71, v87
    v_permlane32_swap_b32 v72, v88
    v_permlane32_swap_b32 v73, v89
    v_permlane32_swap_b32 v74, v90
    v_permlane32_swap_b32 v75, v91
    v_permlane32_swap_b32 v76, v92
    v_permlane32_swap_b32 v77, v93
    v_permlane32_swap_b32 v78, v94
    v_permlane32_swap_b32 v79, v95
    v_pk_add_f32 v[64:65], v[64:65], v[80:81]
    v_pk_add_f32 v[66:67], v[66:67], v[82:83]
    v_pk_add_f32 v[68:69], v[68:69], v[84:85]
    v_pk_add_f32 v[70:71], v[70:71], v[86:87]
    v_pk_add_f32 v[72:73], v[72:73], v[88:89]
    v_pk_add_f32 v[74:75], v[74:75], v[90:91]
    buffer_load_dwordx4 v[156:159], v2, s[8:11], s60 offen nt
    s_add_u32 s60, s60, 0x2000
    v_pk_add_f32 v[76:77], v[76:77], v[92:93]
    v_pk_add_f32 v[78:79], v[78:79], v[94:95]
    v_permlane16_swap_b32 v64, v72
    v_permlane16_swap_b32 v65, v73
    v_permlane16_swap_b32 v66, v74
    v_permlane16_swap_b32 v67, v75
    v_permlane16_swap_b32 v68, v76
    v_permlane16_swap_b32 v69, v77
    v_permlane16_swap_b32 v70, v78
    v_permlane16_swap_b32 v71, v79
    v_pk_add_f32 v[64:65], v[64:65], v[72:73]
    v_pk_add_f32 v[66:67], v[66:67], v[74:75]
    v_pk_add_f32 v[68:69], v[68:69], v[76:77]
    v_pk_add_f32 v[70:71], v[70:71], v[78:79]
    v_add_f32_dpp v116, v64, v64 row_ror:8 row_mask:0xf bank_mask:0x3
    v_add_f32_dpp v117, v65, v65 row_ror:8 row_mask:0xf bank_mask:0x3
    v_add_f32_dpp v118, v66, v66 row_ror:8 row_mask:0xf bank_mask:0x3
    v_add_f32_dpp v119, v67, v67 row_ror:8 row_mask:0xf bank_mask:0x3
    v_add_f32_dpp v116, v68, v68 row_ror:8 row_mask:0xf bank_mask:0xc
    v_add_f32_dpp v117, v69, v69 row_ror:8 row_mask:0xf bank_mask:0xc
    v_add_f32_dpp v118, v70, v70 row_ror:8 row_mask:0xf bank_mask:0xc
    v_add_f32_dpp v119, v71, v71 row_ror:8 row_mask:0xf bank_mask:0xc
    ds_write_b128 v21, v[116:119] offset:20480
    s_add_u32 s101, s101, 0x01010101
    v_mov_b32 v4, s101
    s_bfe_u32 s44, s101, 0x80000
    s_mov_b32 s28, 0x07060500
    s_bfe_u32 s45, s101, 0x80008
    s_mov_b32 s29, 0x07060501
    s_bfe_u32 s46, s101, 0x80010
    s_mov_b32 s30, 0x07060502
    s_bfe_u32 s47, s101, 0x80018
    s_mov_b32 s31, 0x07060503
    s_waitcnt lgkmcnt(0)
    s_barrier
    s_cmp_lg_u32 s52, 0
    s_cbranch_scc1 L_noq
    ds_read_b128 v[64:67], v2 offset:12288
    ds_read_b128 v[68:71], v2 offset:13312
    ds_read_b128 v[72:75], v2 offset:14336
    ds_read_b128 v[76:79], v2 offset:15360
    ds_read_b128 v[80:83], v2 offset:16384
    ds_read_b128 v[84:87], v2 offset:17408
    ds_read_b128 v[88:91], v2 offset:18432
    ds_read_b128 v[92:95], v2 offset:20480
    ds_read_b128 v[96:99], v2 offset:21504
    ds_read_b128 v[100:103], v2 offset:22528
    ds_read_b128 v[104:107], v2 offset:23552
    ds_read_b128 v[108:111], v2 offset:24576
    ds_read_b128 v[112:115], v2 offset:25600
    ds_read_b128 v[116:119], v2 offset:26624
    v_and_b32 v21, 15, v1
    v_lshlrev_b32 v21, 4, v21
    v_lshl_add_u32 v22, v20, 14, v21
    v_lshl_add_u32 v21, v20, 13, v21
    s_waitcnt lgkmcnt(7)
    v_pk_add_f32 v[64:65], v[64:65], v[68:69]
    v_pk_add_f32 v[66:67], v[66:67], v[70:71]
    v_pk_add_f32 v[72:73], v[72:73], v[76:77]
    v_pk_add_f32 v[74:75], v[74:75], v[78:79]
    v_pk_add_f32 v[80:81], v[80:81], v[84:85]
    v_pk_add_f32 v[82:83], v[82:83], v[86:87]
    v_pk_add_f32 v[64:65], v[64:65], v[72:73]
    v_pk_add_f32 v[66:67], v[66:67], v[74:75]
    v_pk_add_f32 v[80:81], v[80:81], v[88:89]
    v_pk_add_f32 v[82:83], v[82:83], v[90:91]
    v_pk_add_f32 v[64:65], v[64:65], v[80:81]
    v_pk_add_f32 v[66:67], v[66:67], v[82:83]
    v_add_u32 v64, 0x80, v64
    v_add_u32 v65, 0x80, v65
    v_add_u32 v66, 0x80, v66
    v_add_u32 v67, 0x80, v67
    v_perm_b32 v64, v64, v4, s28
    v_perm_b32 v65, v65, v4, s29
    v_perm_b32 v66, v66, v4, s30
    v_perm_b32 v67, v67, v4, s31
    buffer_store_dwordx4 v[64:67], v22, s[48:51], s6 offen sc1
    s_waitcnt lgkmcnt(0)
    v_pk_add_f32 v[92:93], v[92:93], v[96:97]
    v_pk_add_f32 v[94:95], v[94:95], v[98:99]
    v_pk_add_f32 v[100:101], v[100:101], v[104:105]
    v_pk_add_f32 v[102:103], v[102:103], v[106:107]
    v_pk_add_f32 v[108:109], v[108:109], v[112:113]
    v_pk_add_f32 v[110:111], v[110:111], v[114:115]
    v_pk_add_f32 v[92:93], v[92:93], v[100:101]
    v_pk_add_f32 v[94:95], v[94:95], v[102:103]
    v_pk_add_f32 v[108:109], v[108:109], v[116:117]
    v_pk_add_f32 v[110:111], v[110:111], v[118:119]
    v_pk_add_f32 v[92:93], v[92:93], v[108:109]
    v_pk_add_f32 v[94:95], v[94:95], v[110:111]
    v_add_u32 v92, 0x80, v92
    v_add_u32 v93, 0x80, v93
    v_add_u32 v94, 0x80, v94
    v_add_u32 v95, 0x80, v95
    v_perm_b32 v92, v92, v4, s28
    v_perm_b32 v93, v93, v4, s29
    v_perm_b32 v94, v94, v4, s30
    v_perm_b32 v95, v95, v4, s31
    s_cmp_ge_u32 s55, 56
    s_cbranch_scc1 L_noq
    buffer_store_dwordx4 v[92:95], v21, s[48:51], s7 offen sc1
L_noq:
    s_nop 4
    s_waitcnt vmcnt(3)
    s_cmp_lg_u32 s96, 0
    s_cbranch_scc1 1
    s_waitcnt vmcnt(2)
    buffer_load_dwordx4 v[160:163], v2, s[8:11], s60 offen nt
    s_add_u32 s60, s60, 0x2000
    s_waitcnt vmcnt(3)
    s_cmp_lg_u32 s96, 0
    s_cbranch_scc1 1
    s_waitcnt vmcnt(2)
    buffer_load_dwordx4 v[164:167], v2, s[8:11], s60 offen nt
    s_add_u32 s60, s60, 0x2000
    s_waitcnt vmcnt(3)
    s_cmp_lg_u32 s96, 0
    s_cbranch_scc1 1
    s_waitcnt vmcnt(2)
    buffer_load_dwordx4 v[168:171], v2, s[8:11], s60 offen nt
    s_add_u32 s60, s60, 0x2000
    s_waitcnt vmcnt(3)
    s_cmp_lg_u32 s96, 0
    s_cbranch_scc1 1
    s_waitcnt vmcnt(2)
    buffer_load_dwordx4 v[172:175], v2, s[8:11], s60 offen nt
    s_add_u32 s60, s60, 0x2000
    s_cmp_lg_u32 s52, 1
    s_cbranch_scc1 L_p2
    s_lshl_b32 s68, s3, 11
    v_lshlrev_b32 v22, 4, v1
    s_add_u32 s69, s68, 65536
    s_add_u32 s70, s68, 131072
    s_add_u32 s71, s68, 196608
    s_lshl_b32 s5, s53, 13
    s_mul_i32 s7, s55, 112
    s_add_u32 s5, s5, s7
    s_add_u32 s72, s5, 262144
    v_min_u32 v21, 6, v16
    v_lshlrev_b32 v21, 4, v21
    v_lshl_add_u32 v21, v19, 15, v21
    buffer_load_dwordx4 v[64:67], v22, s[48:51], s68 offen offset:0 sc1
    buffer_load_dwordx4 v[68:71], v22, s[48:51], s68 offen offset:1024 sc1
    buffer_load_dwordx4 v[72:75], v22, s[48:51], s69 offen offset:0 sc1
    buffer_load_dwordx4 v[76:79], v22, s[48:51], s69 offen offset:1024 sc1
    buffer_load_dwordx4 v[80:83], v22, s[48:51], s70 offen offset:0 sc1
    buffer_load_dwordx4 v[84:87], v22, s[48:51], s70 offen offset:1024 sc1
    buffer_load_dwordx4 v[88:91], v22, s[48:51], s71 offen offset:0 sc1
    buffer_load_dwordx4 v[92:95], v22, s[48:51], s71 offen offset:1024 sc1
    buffer_load_dwordx4 v[8:11], v21, s[48:51], s72 offen sc1
L_p2:
    s_nop 4
    s_waitcnt vmcnt(3)
    s_cmp_lg_u32 s96, 0
    s_cbranch_scc1 1
    s_waitcnt vmcnt(2)
    buffer_load_dwordx4 v[176:179], v2, s[8:11], s60 offen nt
    s_add_u32 s60, s60, 0x2000
    s_waitcnt vmcnt(3)
    s_cmp_lg_u32 s96, 0
    s_cbranch_scc1 1
    s_waitcnt vmcnt(2)
    buffer_load_dwordx4 v[180:183], v2, s[8:11], s60 offen nt
    s_add_u32 s60, s60, 0x2000
    s_waitcnt vmcnt(3)
    s_cmp_lg_u32 s96, 0
    s_cbranch_scc1 1
    s_waitcnt vmcnt(2)
    buffer_load_dwordx4 v[184:187], v2, s[8:11], s60 offen nt
    s_add_u32 s60, s60, 0x2000
    s_waitcnt vmcnt(3)
    s_cmp_lg_u32 s96, 0
    s_cbranch_scc1 1
    s_waitcnt vmcnt(2)
    buffer_load_dwordx4 v[188:191], v2, s[8:11], s60 offen nt
    s_add_u32 s60, s60, 0x2000
    s_waitcnt vmcnt(3)
    s_cmp_lg_u32 s96, 0
    s_cbranch_scc1 1
    s_waitcnt vmcnt(2)
    buffer_load_dwordx4 v[192:195], v2, s[8:11], s60 offen nt
    s_add_u32 s60, s60, 0x2000
    s_cmp_lg_u32 s52, 1
    s_cbranch_scc1 L_p3
    s_waitcnt vmcnt(5)
    s_mov_b32 s61, 20000
L_gs_c:
    s_nop 4
    v_xor_b32 v64, s44, v64
    v_xor_b32 v65, s45, v65
    v_xor_b32 v66, s46, v66
    v_xor_b32 v67, s47, v67
    v_xor_b32 v68, s44, v68
    v_xor_b32 v69, s45, v69
    v_xor_b32 v70, s46, v70
    v_xor_b32 v71, s47, v71
    v_xor_b32 v72, s44, v72
    v_xor_b32 v73, s45, v73
    v_xor_b32 v74, s46, v74
    v_xor_b32 v75, s47, v75
    v_xor_b32 v76, s44, v76
    v_xor_b32 v77, s45, v77
    v_xor_b32 v78, s46, v78
    v_xor_b32 v79, s47, v79
    v_xor_b32 v80, s44, v80
    v_xor_b32 v81, s45, v81
    v_xor_b32 v82, s46, v82
    v_xor_b32 v83, s47, v83
    v_xor_b32 v84, s44, v84
    v_xor_b32 v85, s45, v85
    v_xor_b32 v86, s46, v86
    v_xor_b32 v87, s47, v87
    v_xor_b32 v88, s44, v88
    v_xor_b32 v89, s45, v89
    v_xor_b32 v90, s46, v90
    v_xor_b32 v91, s47, v91
    v_xor_b32 v92, s44, v92
    v_xor_b32 v93, s45, v93
    v_xor_b32 v94, s46, v94
    v_xor_b32 v95, s47, v95
    v_xor_b32 v8, s44, v8
    v_xor_b32 v9, s45, v9
    v_xor_b32 v10, s46, v10
    v_xor_b32 v11, s47, v11
    v_or_b32 v60, v64, v65
    v_or_b32 v61, v66, v67
    v_or_b32 v62, v68, v69
    v_or_b32 v63, v70, v71
    v_or3_b32 v60, v60, v72, v73
    v_or3_b32 v61, v61, v74, v75
    v_or3_b32 v62, v62, v76, v77
    v_or3_b32 v63, v63, v78, v79
    v_or3_b32 v60, v60, v80, v81
    v_or3_b32 v61, v61, v82, v83
    v_or3_b32 v62, v62, v84, v85
    v_or3_b32 v63, v63, v86, v87
    v_or3_b32 v60, v60, v88, v89
    v_or3_b32 v61, v61, v90, v91
    v_or3_b32 v62, v62, v92, v93
    v_or3_b32 v63, v63, v94, v95
    v_or3_b32 v60, v60, v8, v9
    v_or3_b32 v61, v61, v10, v11
    v_or3_b32 v60, v60, v61, v62
    v_or_b32 v60, v60, v63
    v_and_b32 v60, 0xff, v60
    v_cmp_ne_u32 vcc, 0, v60
    s_cbranch_vccz L_gs_d
    s_sub_u32 s61, s61, 1
    s_cbranch_scc1 L_gs_d
    buffer_load_dwordx4 v[64:67], v22, s[48:51], s68 offen offset:0 sc1
    buffer_load_dwordx4 v[68:71], v22, s[48:51], s68 offen offset:1024 sc1
    buffer_load_dwordx4 v[72:75], v22, s[48:51], s69 offen offset:0 sc1
    buffer_load_dwordx4 v[76:79], v22, s[48:51], s69 offen offset:1024 sc1
    buffer_load_dwordx4 v[80:83], v22, s[48:51], s70 offen offset:0 sc1
    buffer_load_dwordx4 v[84:87], v22, s[48:51], s70 offen offset:1024 sc1
    buffer_load_dwordx4 v[88:91], v22, s[48:51], s71 offen offset:0 sc1
    buffer_load_dwordx4 v[92:95], v22, s[48:51], s71 offen offset:1024 sc1
    buffer_load_dwordx4 v[8:11], v21, s[48:51], s72 offen sc1
    s_waitcnt vmcnt(0)
    s_branch L_gs_c
L_gs_d:
    s_nop 4
    v_pk_add_f32 v[64:65], v[64:65], v[72:73]
    v_pk_add_f32 v[66:67], v[66:67], v[74:75]
    v_pk_add_f32 v[68:69], v[68:69], v[76:77]
    v_pk_add_f32 v[70:71], v[70:71], v[78:79]
    v_pk_add_f32 v[80:81], v[80:81], v[88:89]
    v_pk_add_f32 v[82:83], v[82:83], v[90:91]
    v_pk_add_f32 v[84:85], v[84:85], v[92:93]
    v_pk_add_f32 v[86:87], v[86:87], v[94:95]
    v_pk_add_f32 v[64:65], v[64:65], v[80:81]
    v_pk_add_f32 v[66:67], v[66:67], v[82:83]
    v_pk_add_f32 v[68:69], v[68:69], v[84:85]
    v_pk_add_f32 v[70:71], v[70:71], v[86:87]
    v_cvt_pk_bf16_f32 v64, v64, v65
    v_cvt_pk_bf16_f32 v65, v66, v67
    v_cvt_pk_bf16_f32 v66, v68, v69
    v_cvt_pk_bf16_f32 v67, v70, v71
    v_lshlrev_b32 v61, 3, v1
    ds_write_b64 v61, v[64:65] offset:6144
    ds_write_b64 v61, v[66:67] offset:6656
    ds_write_b128 v22, v[8:11] offset:7168
    v_mov_b32 v61, 0
    ds_write_b32 v61, v61 offset:9344
L_p3:
    s_nop 4
    s_waitcnt vmcnt(3)
    s_cmp_lg_u32 s96, 0
    s_cbranch_scc1 1
    s_waitcnt vmcnt(2)
    buffer_load_dwordx4 v[196:199], v2, s[8:11], s60 offen nt
    s_add_u32 s60, s60, 0x2000
    s_waitcnt vmcnt(3)
    s_cmp_lg_u32 s96, 0
    s_cbranch_scc1 1
    s_waitcnt vmcnt(2)
    buffer_load_dwordx4 v[200:203], v2, s[8:11], s60 offen nt
    s_add_u32 s60, s60, 0x2000
    s_waitcnt vmcnt(3)
    s_cmp_lg_u32 s96, 0
    s_cbranch_scc1 1
    s_waitcnt vmcnt(2)
    buffer_load_dwordx4 v[204:207], v2, s[8:11], s60 offen nt
    s_add_u32 s60, s60, 0x2000
    s_waitcnt vmcnt(3)
    s_cmp_lg_u32 s96, 0
    s_cbranch_scc1 1
    s_waitcnt vmcnt(2)
    buffer_load_dwordx4 v[208:211], v2, s[8:11], s60 offen nt
    s_add_u32 s60, s60, 0x2000
    v_and_b32 v60, 31, v1
    v_lshlrev_b32 v60, 4, v60
    v_mov_b32 v61, 0
    s_mov_b32 s61, 100000
L_p4:
    s_nop 4
    ds_read_b32 v7, v61 offset:9344
    ds_read_b128 v[8:11], v60 offset:6144
    ds_read_b128 v[12:15], v60 offset:6656
    s_waitcnt lgkmcnt(0)
    v_cmp_eq_u32 vcc, -1, v7
    s_cbranch_vccz L_p4d
    s_sub_u32 s61, s61, 1
    s_cbranch_scc0 L_p4
L_p4d:
    s_nop 4
    s_waitcnt vmcnt(19)
    v_dot2_f32_bf16 v64, v128, v8, 0
    v_dot2_f32_bf16 v66, v128, v12, 0
    v_dot2_f32_bf16 v65, v132, v8, 0
    v_dot2_f32_bf16 v67, v132, v12, 0
    v_dot2_f32_bf16 v64, v129, v9, v64
    v_dot2_f32_bf16 v66, v129, v13, v66
    v_dot2_f32_bf16 v65, v133, v9, v65
    v_dot2_f32_bf16 v67, v133, v13, v67
    v_dot2_f32_bf16 v64, v130, v10, v64
    v_dot2_f32_bf16 v66, v130, v14, v66
    v_dot2_f32_bf16 v65, v134, v10, v65
    v_dot2_f32_bf16 v67, v134, v14, v67
    v_dot2_f32_bf16 v64, v131, v11, v64
    v_dot2_f32_bf16 v66, v131, v15, v66
    v_dot2_f32_bf16 v65, v135, v11, v65
    v_dot2_f32_bf16 v67, v135, v15, v67
    s_nop 1
    v_permlane16_swap_b32 v64, v65
    v_add_f32 v64, v64, v65
    v_permlane16_swap_b32 v66, v67
    v_add_f32 v66, v66, v67
    s_waitcnt vmcnt(17)
    v_dot2_f32_bf16 v68, v136, v8, 0
    v_dot2_f32_bf16 v70, v136, v12, 0
    v_dot2_f32_bf16 v69, v140, v8, 0
    v_dot2_f32_bf16 v71, v140, v12, 0
    v_dot2_f32_bf16 v68, v137, v9, v68
    v_dot2_f32_bf16 v70, v137, v13, v70
    v_dot2_f32_bf16 v69, v141, v9, v69
    v_dot2_f32_bf16 v71, v141, v13, v71
    v_dot2_f32_bf16 v68, v138, v10, v68
    v_dot2_f32_bf16 v70, v138, v14, v70
    v_dot2_f32_bf16 v69, v142, v10, v69
    v_dot2_f32_bf16 v71, v142, v14, v71
    v_dot2_f32_bf16 v68, v139, v11, v68
    v_dot2_f32_bf16 v70, v139, v15, v70
    v_dot2_f32_bf16 v69, v143, v11, v69
    v_dot2_f32_bf16 v71, v143, v15, v71
    s_nop 1
    v_permlane16_swap_b32 v68, v69
    v_add_f32 v68, v68, v69
    v_permlane16_swap_b32 v70, v71
    v_add_f32 v70, v70, v71
    v_add_f32_dpp v64, v64, v64 row_ror:8 row_mask:0xf bank_mask:0x3
    s_nop 1
    v_add_f32_dpp v64, v68, v68 row_ror:8 row_mask:0xf bank_mask:0xc
    v_add_f32_dpp v66, v66, v66 row_ror:8 row_mask:0xf bank_mask:0x3
    s_nop 1
    v_add_f32_dpp v66, v70, v70 row_ror:8 row_mask:0xf bank_mask:0xc
    s_waitcnt vmcnt(3)
    s_cmp_lg_u32 s96, 0
    s_cbranch_scc1 1
    s_waitcnt vmcnt(2)
    buffer_load_dwordx4 v[212:215], v2, s[8:11], s60 offen nt
    s_add_u32 s60, s60, 0x2000
    s_waitcnt vmcnt(16)
    v_dot2_f32_bf16 v72, v144, v8, 0
    v_dot2_f32_bf16 v74, v144, v12, 0
    v_dot2_f32_bf16 v73, v148, v8, 0
    v_dot2_f32_bf16 v75, v148, v12, 0
    v_dot2_f32_bf16 v72, v145, v9, v72
    v_dot2_f32_bf16 v74, v145, v13, v74
    v_dot2_f32_bf16 v73, v149, v9, v73
    v_dot2_f32_bf16 v75, v149, v13, v75
    v_dot2_f32_bf16 v72, v146, v10, v72
    v_dot2_f32_bf16 v74, v146, v14, v74
    v_dot2_f32_bf16 v73, v150, v10, v73
    v_dot2_f32_bf16 v75, v150, v14, v75
    v_dot2_f32_bf16 v72, v147, v11, v72
    v_dot2_f32_bf16 v74, v147, v15, v74
    v_dot2_f32_bf16 v73, v151, v11, v73
    v_dot2_f32_bf16 v75, v151, v15, v75
    s_nop 1
    v_permlane16_swap_b32 v72, v73
    v_add_f32 v72, v72, v73
    v_permlane16_swap_b32 v74, v75
    v_add_f32 v74, v74, v75
    s_waitcnt vmcnt(14)
    v_dot2_f32_bf16 v76, v152, v8, 0
    v_dot2_f32_bf16 v78, v152, v12, 0
    v_dot2_f32_bf16 v77, v156, v8, 0
    v_dot2_f32_bf16 v79, v156, v12, 0
    v_dot2_f32_bf16 v76, v153, v9, v76
    v_dot2_f32_bf16 v78, v153, v13, v78
    v_dot2_f32_bf16 v77, v157, v9, v77
    v_dot2_f32_bf16 v79, v157, v13, v79
    v_dot2_f32_bf16 v76, v154, v10, v76
    v_dot2_f32_bf16 v78, v154, v14, v78
    v_dot2_f32_bf16 v77, v158, v10, v77
    v_dot2_f32_bf16 v79, v158, v14, v79
    v_dot2_f32_bf16 v76, v155, v11, v76
    v_dot2_f32_bf16 v78, v155, v15, v78
    v_dot2_f32_bf16 v77, v159, v11, v77
    v_dot2_f32_bf16 v79, v159, v15, v79
    s_nop 1
    v_permlane16_swap_b32 v76, v77
    v_add_f32 v76, v76, v77
    v_permlane16_swap_b32 v78, v79
    v_add_f32 v78, v78, v79
    v_add_f32_dpp v72, v72, v72 row_ror:8 row_mask:0xf bank_mask:0x3
    s_nop 1
    v_add_f32_dpp v72, v76, v76 row_ror:8 row_mask:0xf bank_mask:0xc
    v_add_f32_dpp v74, v74, v74 row_ror:8 row_mask:0xf bank_mask:0x3
    s_nop 1
    v_add_f32_dpp v74, v78, v78 row_ror:8 row_mask:0xf bank_mask:0xc
    v_add_f32_dpp v64, v64, v64 row_half_mirror row_mask:0xf bank_mask:0x5
    s_nop 1
    v_add_f32_dpp v64, v72, v72 row_half_mirror row_mask:0xf bank_mask:0xa
    v_add_f32_dpp v66, v66, v66 row_half_mirror row_mask:0xf bank_mask:0x5
    s_nop 1
    v_add_f32_dpp v66, v74, v74 row_half_mirror row_mask:0xf bank_mask:0xa
    s_waitcnt vmcnt(3)
    s_cmp_lg_u32 s96, 0
    s_cbranch_scc1 1
    s_waitcnt vmcnt(2)
    buffer_load_dwordx4 v[216:219], v2, s[8:11], s60 offen nt
    s_add_u32 s60, s60, 0x2000
    s_waitcnt vmcnt(13)
    v_dot2_f32_bf16 v80, v160, v8, 0
    v_dot2_f32_bf16 v82, v160, v12, 0
    v_dot2_f32_bf16 v81, v164, v8, 0
    v_dot2_f32_bf16 v83, v164, v12, 0
    v_dot2_f32_bf16 v80, v161, v9, v80
    v_dot2_f32_bf16 v82, v161, v13, v82
    v_dot2_f32_bf16 v81, v165, v9, v81
    v_dot2_f32_bf16 v83, v165, v13, v83
    v_dot2_f32_bf16 v80, v162, v10, v80
    v_dot2_f32_bf16 v82, v162, v14, v82
    v_dot2_f32_bf16 v81, v166, v10, v81
    v_dot2_f32_bf16 v83, v166, v14, v83
    v_dot2_f32_bf16 v80, v163, v11, v80
    v_dot2_f32_bf16 v82, v163, v15, v82
    v_dot2_f32_bf16 v81, v167, v11, v81
    v_dot2_f32_bf16 v83, v167, v15, v83
    s_nop 1
    v_permlane16_swap_b32 v80, v81
    v_add_f32 v80, v80, v81
    v_permlane16_swap_b32 v82, v83
    v_add_f32 v82, v82, v83
    s_waitcnt vmcnt(11)
    v_dot2_f32_bf16 v84, v168, v8, 0
    v_dot2_f32_bf16 v86, v168, v12, 0
    v_dot2_f32_bf16 v85, v172, v8, 0
    v_dot2_f32_bf16 v87, v172, v12, 0
    v_dot2_f32_bf16 v84, v169, v9, v84
    v_dot2_f32_bf16 v86, v169, v13, v86
    v_dot2_f32_bf16 v85, v173, v9, v85
    v_dot2_f32_bf16 v87, v173, v13, v87
    v_dot2_f32_bf16 v84, v170, v10, v84
    v_dot2_f32_bf16 v86, v170, v14, v86
    v_dot2_f32_bf16 v85, v174, v10, v85
    v_dot2_f32_bf16 v87, v174, v14, v87
    v_dot2_f32_bf16 v84, v171, v11, v84
    v_dot2_f32_bf16 v86, v171, v15, v86
    v_dot2_f32_bf16 v85, v175, v11, v85
    v_dot2_f32_bf16 v87, v175, v15, v87
    s_nop 1
    v_permlane16_swap_b32 v84, v85
    v_add_f32 v84, v84, v85
    v_permlane16_swap_b32 v86, v87
    v_add_f32 v86, v86, v87
    v_add_f32_dpp v80, v80, v80 row_ror:8 row_mask:0xf bank_mask:0x3
    s_nop 1
    v_add_f32_dpp v80, v84, v84 row_ror:8 row_mask:0xf bank_mask:0xc
    v_add_f32_dpp v82, v82, v82 row_ror:8 row_mask:0xf bank_mask:0x3
    s_nop 1
    v_add_f32_dpp v82, v86, v86 row_ror:8 row_mask:0xf bank_mask:0xc
    s_waitcnt vmcnt(3)
    s_cmp_lg_u32 s96, 0
    s_cbranch_scc1 1
    s_waitcnt vmcnt(2)
    buffer_load_dwordx4 v[220:223], v2, s[8:11], s60 offen nt
    s_add_u32 s60, s60, 0x2000
    s_waitcnt vmcnt(10)
    v_dot2_f32_bf16 v88, v176, v8, 0
    v_dot2_f32_bf16 v90, v176, v12, 0
    v_dot2_f32_bf16 v89, v180, v8, 0
    v_dot2_f32_bf16 v91, v180, v12, 0
    v_dot2_f32_bf16 v88, v177, v9, v88
    v_dot2_f32_bf16 v90, v177, v13, v90
    v_dot2_f32_bf16 v89, v181, v9, v89
    v_dot2_f32_bf16 v91, v181, v13, v91
    v_dot2_f32_bf16 v88, v178, v10, v88
    v_dot2_f32_bf16 v90, v178, v14, v90
    v_dot2_f32_bf16 v89, v182, v10, v89
    v_dot2_f32_bf16 v91, v182, v14, v91
    v_dot2_f32_bf16 v88, v179, v11, v88
    v_dot2_f32_bf16 v90, v179, v15, v90
    v_dot2_f32_bf16 v89, v183, v11, v89
    v_dot2_f32_bf16 v91, v183, v15, v91
    s_nop 1
    v_permlane16_swap_b32 v88, v89
    v_add_f32 v88, v88, v89
    v_permlane16_swap_b32 v90, v91
    v_add_f32 v90, v90, v91
    s_waitcnt vmcnt(8)
    v_dot2_f32_bf16 v92, v184, v8, 0
    v_dot2_f32_bf16 v94, v184, v12, 0
    v_dot2_f32_bf16 v93, v188, v8, 0
    v_dot2_f32_bf16 v95, v188, v12, 0
    v_dot2_f32_bf16 v92, v185, v9, v92
    v_dot2_f32_bf16 v94, v185, v13, v94
    v_dot2_f32_bf16 v93, v189, v9, v93
    v_dot2_f32_bf16 v95, v189, v13, v95
    v_dot2_f32_bf16 v92, v186, v10, v92
    v_dot2_f32_bf16 v94, v186, v14, v94
    v_dot2_f32_bf16 v93, v190, v10, v93
    v_dot2_f32_bf16 v95, v190, v14, v95
    v_dot2_f32_bf16 v92, v187, v11, v92
    v_dot2_f32_bf16 v94, v187, v15, v94
    v_dot2_f32_bf16 v93, v191, v11, v93
    v_dot2_f32_bf16 v95, v191, v15, v95
    s_nop 1
    v_permlane16_swap_b32 v92, v93
    v_add_f32 v92, v92, v93
    v_permlane16_swap_b32 v94, v95
    v_add_f32 v94, v94, v95
    v_add_f32_dpp v88, v88, v88 row_ror:8 row_mask:0xf bank_mask:0x3
    s_nop 1
    v_add_f32_dpp v88, v92, v92 row_ror:8 row_mask:0xf bank_mask:0xc
    v_add_f32_dpp v90, v90, v90 row_ror:8 row_mask:0xf bank_mask:0x3
    s_nop 1
    v_add_f32_dpp v90, v94, v94 row_ror:8 row_mask:0xf bank_mask:0xc
    v_add_f32_dpp v80, v80, v80 row_half_mirror row_mask:0xf bank_mask:0x5
    s_nop 1
    v_add_f32_dpp v80, v88, v88 row_half_mirror row_mask:0xf bank_mask:0xa
    v_add_f32_dpp v82, v82, v82 row_half_mirror row_mask:0xf bank_mask:0x5
    s_nop 1
    v_add_f32_dpp v82, v90, v90 row_half_mirror row_mask:0xf bank_mask:0xa
    v_cndmask_b32 v60, v80, v64, s[56:57]
    v_cndmask_b32 v64, v64, v80, s[56:57]
    s_nop 1
    v_add_f32_dpp v64, v60, v64 quad_perm:[2,3,0,1] row_mask:0xf bank_mask:0xf
    v_cndmask_b32 v61, v82, v66, s[56:57]
    v_cndmask_b32 v66, v66, v82, s[56:57]
    s_nop 1
    v_add_f32_dpp v66, v61, v66 quad_perm:[2,3,0,1] row_mask:0xf bank_mask:0xf
    s_waitcnt vmcnt(3)
    s_cmp_lg_u32 s96, 0
    s_cbranch_scc1 1
    s_waitcnt vmcnt(2)
    buffer_load_dwordx4 v[224:227], v2, s[8:11], s60 offen nt
    s_add_u32 s60, s60, 0x2000
    s_waitcnt vmcnt(7)
    v_dot2_f32_bf16 v65, v192, v8, 0
    v_dot2_f32_bf16 v69, v192, v12, 0
    v_dot2_f32_bf16 v67, v196, v8, 0
    v_dot2_f32_bf16 v71, v196, v12, 0
    v_dot2_f32_bf16 v65, v193, v9, v65
    v_dot2_f32_bf16 v69, v193, v13, v69
    v_dot2_f32_bf16 v67, v197, v9, v67
    v_dot2_f32_bf16 v71, v197, v13, v71
    v_dot2_f32_bf16 v65, v194, v10, v65
    v_dot2_f32_bf16 v69, v194, v14, v69
    v_dot2_f32_bf16 v67, v198, v10, v67
    v_dot2_f32_bf16 v71, v198, v14, v71
    v_dot2_f32_bf16 v65, v195, v11, v65
    v_dot2_f32_bf16 v69, v195, v15, v69
    v_dot2_f32_bf16 v67, v199, v11, v67
    v_dot2_f32_bf16 v71, v199, v15, v71
    s_nop 1
    v_permlane16_swap_b32 v65, v67
    v_add_f32 v65, v65, v67
    v_permlane16_swap_b32 v69, v71
    v_add_f32 v69, v69, v71
    s_waitcnt vmcnt(5)
    v_dot2_f32_bf16 v68, v200, v8, 0
    v_dot2_f32_bf16 v73, v200, v12, 0
    v_dot2_f32_bf16 v70, v204, v8, 0
    v_dot2_f32_bf16 v75, v204, v12, 0
    v_dot2_f32_bf16 v68, v201, v9, v68
    v_dot2_f32_bf16 v73, v201, v13, v73
    v_dot2_f32_bf16 v70, v205, v9, v70
    v_dot2_f32_bf16 v75, v205, v13, v75
    v_dot2_f32_bf16 v68, v202, v10, v68
    v_dot2_f32_bf16 v73, v202, v14, v73
    v_dot2_f32_bf16 v70, v206, v10, v70
    v_dot2_f32_bf16 v75, v206, v14, v75
    v_dot2_f32_bf16 v68, v203, v11, v68
    v_dot2_f32_bf16 v73, v203, v15, v73
    v_dot2_f32_bf16 v70, v207, v11, v70
    v_dot2_f32_bf16 v75, v207, v15, v75
    s_nop 1
    v_permlane16_swap_b32 v68, v70
    v_add_f32 v68, v68, v70
    v_permlane16_swap_b32 v73, v75
    v_add_f32 v73, v73, v75
    v_add_f32_dpp v65, v65, v65 row_ror:8 row_mask:0xf bank_mask:0x3
    s_nop 1
    v_add_f32_dpp v65, v68, v68 row_ror:8 row_mask:0xf bank_mask:0xc
    v_add_f32_dpp v69, v69, v69 row_ror:8 row_mask:0xf bank_mask:0x3
    s_nop 1
    v_add_f32_dpp v69, v73, v73 row_ror:8 row_mask:0xf bank_mask:0xc
    s_waitcnt vmcnt(3)
    s_cmp_lg_u32 s96, 0
    s_cbranch_scc1 1
    s_waitcnt vmcnt(2)
    buffer_load_dwordx4 v[228:231], v2, s[8:11], s60 offen nt
    s_add_u32 s60, s60, 0x2000
    s_waitcnt vmcnt(4)
    v_dot2_f32_bf16 v77, v208, v8, 0
    v_dot2_f32_bf16 v76, v208, v12, 0
    v_dot2_f32_bf16 v79, v212, v8, 0
    v_dot2_f32_bf16 v78, v212, v12, 0
    v_dot2_f32_bf16 v77, v209, v9, v77
    v_dot2_f32_bf16 v76, v209, v13, v76
    v_dot2_f32_bf16 v79, v213, v9, v79
    v_dot2_f32_bf16 v78, v213, v13, v78
    v_dot2_f32_bf16 v77, v210, v10, v77
    v_dot2_f32_bf16 v76, v210, v14, v76
    v_dot2_f32_bf16 v79, v214, v10, v79
    v_dot2_f32_bf16 v78, v214, v14, v78
    v_dot2_f32_bf16 v77, v211, v11, v77
    v_dot2_f32_bf16 v76, v211, v15, v76
    v_dot2_f32_bf16 v79, v215, v11, v79
    v_dot2_f32_bf16 v78, v215, v15, v78
    s_nop 1
    v_permlane16_swap_b32 v77, v79
    v_add_f32 v77, v77, v79
    v_permlane16_swap_b32 v76, v78
    v_add_f32 v76, v76, v78
    s_waitcnt vmcnt(3)
    s_cmp_lg_u32 s96, 0
    s_cbranch_scc1 1
    s_waitcnt vmcnt(2)
    buffer_load_dwordx4 v[232:235], v2, s[8:11], s60 offen nt
    s_add_u32 s60, s60, 0x2000
    s_waitcnt vmcnt(3)
    s_cmp_lg_u32 s96, 0
    s_cbranch_scc1 1
    s_waitcnt vmcnt(2)
    buffer_load_dwordx4 v[236:239], v2, s[8:11], s60 offen nt
    s_add_u32 s60, s60, 0x2000
    s_waitcnt vmcnt(4)
    v_dot2_f32_bf16 v72, v216, v8, 0
    v_dot2_f32_bf16 v81, v216, v12, 0
    v_dot2_f32_bf16 v74, v220, v8, 0
    v_dot2_f32_bf16 v83, v220, v12, 0
    v_dot2_f32_bf16 v72, v217, v9, v72
    v_dot2_f32_bf16 v81, v217, v13, v81
    v_dot2_f32_bf16 v74, v221, v9, v74
    v_dot2_f32_bf16 v83, v221, v13, v83
    v_dot2_f32_bf16 v72, v218, v10, v72
    v_dot2_f32_bf16 v81, v218, v14, v81
    v_dot2_f32_bf16 v74, v222, v10, v74
    v_dot2_f32_bf16 v83, v222, v14, v83
    v_dot2_f32_bf16 v72, v219, v11, v72
    v_dot2_f32_bf16 v81, v219, v15, v81
    v_dot2_f32_bf16 v74, v223, v11, v74
    v_dot2_f32_bf16 v83, v223, v15, v83
    s_nop 1
    v_permlane16_swap_b32 v72, v74
    v_add_f32 v72, v72, v74
    v_permlane16_swap_b32 v81, v83
    v_add_f32 v81, v81, v83
    v_add_f32_dpp v77, v77, v77 row_ror:8 row_mask:0xf bank_mask:0x3
    s_nop 1
    v_add_f32_dpp v77, v72, v72 row_ror:8 row_mask:0xf bank_mask:0xc
    v_add_f32_dpp v76, v76, v76 row_ror:8 row_mask:0xf bank_mask:0x3
    s_nop 1
    v_add_f32_dpp v76, v81, v81 row_ror:8 row_mask:0xf bank_mask:0xc
    v_add_f32_dpp v65, v65, v65 row_half_mirror row_mask:0xf bank_mask:0x5
    s_nop 1
    v_add_f32_dpp v65, v77, v77 row_half_mirror row_mask:0xf bank_mask:0xa
    v_add_f32_dpp v69, v69, v69 row_half_mirror row_mask:0xf bank_mask:0x5
    s_nop 1
    v_add_f32_dpp v69, v76, v76 row_half_mirror row_mask:0xf bank_mask:0xa
    s_waitcnt vmcnt(3)
    s_cmp_lg_u32 s96, 0
    s_cbranch_scc1 1
    s_waitcnt vmcnt(2)
    buffer_load_dwordx4 v[240:243], v2, s[8:11], s60 offen nt
    s_add_u32 s60, s60, 0x2000
    s_waitcnt vmcnt(3)
    s_cmp_lg_u32 s96, 0
    s_cbranch_scc1 1
    s_waitcnt vmcnt(2)
    buffer_load_dwordx4 v[244:247], v2, s[8:11], s60 offen nt
    s_add_u32 s60, s60, 0x2000
    s_waitcnt vmcnt(4)
    v_dot2_f32_bf16 v85, v224, v8, 0
    v_dot2_f32_bf16 v84, v224, v12, 0
    v_dot2_f32_bf16 v87, v228, v8, 0
    v_dot2_f32_bf16 v86, v228, v12, 0
    v_dot2_f32_bf16 v85, v225, v9, v85
    v_dot2_f32_bf16 v84, v225, v13, v84
    v_dot2_f32_bf16 v87, v229, v9, v87
    v_dot2_f32_bf16 v86, v229, v13, v86
    v_dot2_f32_bf16 v85, v226, v10, v85
    v_dot2_f32_bf16 v84, v226, v14, v84
    v_dot2_f32_bf16 v87, v230, v10, v87
    v_dot2_f32_bf16 v86, v230, v14, v86
    v_dot2_f32_bf16 v85, v227, v11, v85
    v_dot2_f32_bf16 v84, v227, v15, v84
    v_dot2_f32_bf16 v87, v231, v11, v87
    v_dot2_f32_bf16 v86, v231, v15, v86
    s_nop 1
    v_permlane16_swap_b32 v85, v87
    v_add_f32 v85, v85, v87
    v_permlane16_swap_b32 v84, v86
    v_add_f32 v84, v84, v86
    s_waitcnt vmcnt(3)
    s_cmp_lg_u32 s96, 0
    s_cbranch_scc1 1
    s_waitcnt vmcnt(2)
    buffer_load_dwordx4 v[248:251], v2, s[8:11], s60 offen nt
    s_add_u32 s60, s60, 0x2000
    s_waitcnt vmcnt(3)
    s_cmp_lg_u32 s96, 0
    s_cbranch_scc1 1
    s_waitcnt vmcnt(2)
    buffer_load_dwordx4 v[252:255], v2, s[8:11], s60 offen nt
    s_add_u32 s60, s60, 0x2000
    s_waitcnt vmcnt(4)
    v_dot2_f32_bf16 v89, v232, v8, 0
    v_dot2_f32_bf16 v93, v232, v12, 0
    v_dot2_f32_bf16 v91, v236, v8, 0
    v_dot2_f32_bf16 v95, v236, v12, 0
    v_dot2_f32_bf16 v89, v233, v9, v89
    v_dot2_f32_bf16 v93, v233, v13, v93
    v_dot2_f32_bf16 v91, v237, v9, v91
    v_dot2_f32_bf16 v95, v237, v13, v95
    v_dot2_f32_bf16 v89, v234, v10, v89
    v_dot2_f32_bf16 v93, v234, v14, v93
    v_dot2_f32_bf16 v91, v238, v10, v91
    v_dot2_f32_bf16 v95, v238, v14, v95
    v_dot2_f32_bf16 v89, v235, v11, v89
    v_dot2_f32_bf16 v93, v235, v15, v93
    v_dot2_f32_bf16 v91, v239, v11, v91
    v_dot2_f32_bf16 v95, v239, v15, v95
    s_nop 1
    v_permlane16_swap_b32 v89, v91
    v_add_f32 v89, v89, v91
    v_permlane16_swap_b32 v93, v95
    v_add_f32 v93, v93, v95
    v_add_f32_dpp v85, v85, v85 row_ror:8 row_mask:0xf bank_mask:0x3
    s_nop 1
    v_add_f32_dpp v85, v89, v89 row_ror:8 row_mask:0xf bank_mask:0xc
    v_add_f32_dpp v84, v84, v84 row_ror:8 row_mask:0xf bank_mask:0x3
    s_nop 1
    v_add_f32_dpp v84, v93, v93 row_ror:8 row_mask:0xf bank_mask:0xc
    s_cmp_lg_u32 s52, 6
    s_cbranch_scc1 L_pq6
    s_cmp_ge_u32 s55, 56
    s_cbranch_scc1 L_pq6
    v_lshlrev_b32 v25, 5, v1
    s_lshl_b32 s63, s53, 17
    s_add_u32 s63, s63, 524288
    s_mul_i32 s5, s55, 2304
    s_add_u32 s63, s63, s5
    buffer_load_dword v24, v25, s[48:51], s63 offen sc1
L_pq6:
    s_nop 4
    s_cmp_lg_u32 s52, 4
    s_cbranch_scc1 L_pq4
    v_lshlrev_b32 v25, 5, v1
    buffer_load_dword v24, v25, s[48:51], s62 offen sc1
L_pq4:
    s_nop 4
    s_waitcnt vmcnt(3)
    s_cmp_lg_u32 s96, 0
    s_cbranch_scc1 1
    s_waitcnt vmcnt(2)
    s_mov_b32 s60, 0
    buffer_load_dwordx4 v[24:27], v2, s[12:15], s60 offen nt
    s_add_u32 s60, s60, 0x2000
    s_waitcnt vmcnt(3)
    s_cmp_lg_u32 s96, 0
    s_cbranch_scc1 1
    s_waitcnt vmcnt(2)
    buffer_load_dwordx4 v[28:31], v2, s[12:15], s60 offen nt
    s_add_u32 s60, s60, 0x2000
    s_waitcnt vmcnt(4)
    v_dot2_f32_bf16 v92, v240, v8, 0
    v_dot2_f32_bf16 v88, v240, v12, 0
    v_dot2_f32_bf16 v94, v244, v8, 0
    v_dot2_f32_bf16 v90, v244, v12, 0
    v_dot2_f32_bf16 v92, v241, v9, v92
    v_dot2_f32_bf16 v88, v241, v13, v88
    v_dot2_f32_bf16 v94, v245, v9, v94
    v_dot2_f32_bf16 v90, v245, v13, v90
    v_dot2_f32_bf16 v92, v242, v10, v92
    v_dot2_f32_bf16 v88, v242, v14, v88
    v_dot2_f32_bf16 v94, v246, v10, v94
    v_dot2_f32_bf16 v90, v246, v14, v90
    v_dot2_f32_bf16 v92, v243, v11, v92
    v_dot2_f32_bf16 v88, v243, v15, v88
    v_dot2_f32_bf16 v94, v247, v11, v94
    v_dot2_f32_bf16 v90, v247, v15, v90
    s_nop 1
    v_permlane16_swap_b32 v92, v94
    v_add_f32 v92, v92, v94
    v_permlane16_swap_b32 v88, v90
    v_add_f32 v88, v88, v90
    s_waitcnt vmcnt(3)
    s_cmp_lg_u32 s96, 0
    s_cbranch_scc1 1
    s_waitcnt vmcnt(2)
    buffer_load_dwordx4 v[32:35], v2, s[12:15], s60 offen nt
    s_add_u32 s60, s60, 0x2000
    s_waitcnt vmcnt(3)
    s_cmp_lg_u32 s96, 0
    s_cbranch_scc1 1
    s_waitcnt vmcnt(2)
    buffer_load_dwordx4 v[36:39], v2, s[12:15], s60 offen nt
    s_add_u32 s60, s60, 0x2000
    s_waitcnt vmcnt(4)
    v_dot2_f32_bf16 v80, v248, v8, 0
    v_dot2_f32_bf16 v67, v248, v12, 0
    v_dot2_f32_bf16 v82, v252, v8, 0
    v_dot2_f32_bf16 v71, v252, v12, 0
    v_dot2_f32_bf16 v80, v249, v9, v80
    v_dot2_f32_bf16 v67, v249, v13, v67
    v_dot2_f32_bf16 v82, v253, v9, v82
    v_dot2_f32_bf16 v71, v253, v13, v71
    v_dot2_f32_bf16 v80, v250, v10, v80
    v_dot2_f32_bf16 v67, v250, v14, v67
    v_dot2_f32_bf16 v82, v254, v10, v82
    v_dot2_f32_bf16 v71, v254, v14, v71
    v_dot2_f32_bf16 v80, v251, v11, v80
    v_dot2_f32_bf16 v67, v251, v15, v67
    v_dot2_f32_bf16 v82, v255, v11, v82
    v_dot2_f32_bf16 v71, v255, v15, v71
    s_nop 1
    v_permlane16_swap_b32 v80, v82
    v_add_f32 v80, v80, v82
    v_permlane16_swap_b32 v67, v71
    v_add_f32 v67, v67, v71
    v_add_f32_dpp v92, v92, v92 row_ror:8 row_mask:0xf bank_mask:0x3
    s_nop 1
    v_add_f32_dpp v92, v80, v80 row_ror:8 row_mask:0xf bank_mask:0xc
    v_add_f32_dpp v88, v88, v88 row_ror:8 row_mask:0xf bank_mask:0x3
    s_nop 1
    v_add_f32_dpp v88, v67, v67 row_ror:8 row_mask:0xf bank_mask:0xc
    v_add_f32_dpp v85, v85, v85 row_half_mirror row_mask:0xf bank_mask:0x5
    s_nop 1
    v_add_f32_dpp v85, v92, v92 row_half_mirror row_mask:0xf bank_mask:0xa
    v_add_f32_dpp v84, v84, v84 row_half_mirror row_mask:0xf bank_mask:0x5
    s_nop 1
    v_add_f32_dpp v84, v88, v88 row_half_mirror row_mask:0xf bank_mask:0xa
    v_cndmask_b32 v60, v85, v65, s[56:57]
    v_cndmask_b32 v65, v65, v85, s[56:57]
    s_nop 1
    v_add_f32_dpp v65, v60, v65 quad_perm:[2,3,0,1] row_mask:0xf bank_mask:0xf
    v_cndmask_b32 v61, v84, v69, s[56:57]
    v_cndmask_b32 v69, v69, v84, s[56:57]
    s_nop 1
    v_add_f32_dpp v69, v61, v69 quad_perm:[2,3,0,1] row_mask:0xf bank_mask:0xf
    v_cndmask_b32 v60, v65, v64, s[58:59]
    v_cndmask_b32 v64, v64, v65, s[58:59]
    s_nop 1
    v_add_f32_dpp v64, v60, v64 quad_perm:[1,0,3,2] row_mask:0xf bank_mask:0xf
    v_cndmask_b32 v61, v69, v66, s[58:59]
    v_cndmask_b32 v66, v66, v69, s[58:59]
    s_nop 1
    v_add_f32_dpp v66, v61, v66 quad_perm:[1,0,3,2] row_mask:0xf bank_mask:0xf
    v_cvt_pk_bf16_f32 v60, v64, v66
    v_lshlrev_b32 v8, 16, v60
    v_and_b32 v9, 0xffff0000, v60
    v_mov_b32 v10, v8
    v_mov_b32 v11, v9
    s_nop 1
    v_permlane32_swap_b32 v10, v11
    v_max_f32 v10, v10, v11
    s_nop 1
    v_max_f32_dpp v10, v10, v10 row_ror:8 row_mask:0xf bank_mask:0xf
    s_nop 1
    v_max_f32_dpp v10, v10, v10 row_ror:4 row_mask:0xf bank_mask:0xf
    s_nop 1
    v_max_f32_dpp v10, v10, v10 row_ror:2 row_mask:0xf bank_mask:0xf
    s_nop 1
    v_max_f32_dpp v10, v10, v10 row_ror:1 row_mask:0xf bank_mask:0xf
    v_mov_b32 v11, v10
    s_nop 1
    v_permlane16_swap_b32 v10, v11
    v_max_f32 v10, v10, v11
    s_nop 0
    v_readlane_b32 s76, v10, 0
    v_readlane_b32 s77, v10, 32
    s_nop 0
    v_subrev_f32 v8, s76, v8
    v_mul_f32 v8, s66, v8
    v_exp_f32 v8, v8
    v_subrev_f32 v9, s77, v9
    v_mul_f32 v9, s66, v9
    v_exp_f32 v9, v9
    s_nop 0
    v_cvt_pk_bf16_f32 v60, v8, v9
    v_lshlrev_b32 v13, 8, v3
    v_lshl_add_u32 v13, v23, 7, v13
    v_lshl_add_u32 v14, v5, 1, v13
    ds_write_b16 v14, v60 offset:9472
    ds_write_b16_d16_hi v14, v60 offset:9536
    ds_read_b128 v[96:99], v13 offset:9472
    ds_read_b128 v[100:103], v13 offset:9488
    ds_read_b128 v[104:107], v13 offset:9504
    ds_read_b128 v[108:111], v13 offset:9520
    ds_read_b128 v[112:115], v13 offset:9536
    ds_read_b128 v[116:119], v13 offset:9552
    ds_read_b128 v[120:123], v13 offset:9568
    ds_read_b128 v[124:127], v13 offset:9584
    v_permlane32_swap_b32 v8, v9
    v_add_f32 v11, v8, v9
    s_nop 1
    v_add_f32_dpp v11, v11, v11 row_ror:8 row_mask:0xf bank_mask:0xf
    s_nop 1
    v_add_f32_dpp v11, v11, v11 row_ror:4 row_mask:0xf bank_mask:0xf
    s_nop 1
    v_add_f32_dpp v11, v11, v11 row_ror:2 row_mask:0xf bank_mask:0xf
    s_nop 1
    v_add_f32_dpp v11, v11, v11 row_ror:1 row_mask:0xf bank_mask:0xf
    v_mov_b32 v9, v11
    s_nop 1
    v_permlane16_swap_b32 v11, v9
    v_add_f32 v11, v11, v9
    v_lshlrev_b32 v12, 3, v3
    v_lshl_add_u32 v12, v23, 6, v12
    ds_write_b64 v12, v[10:11] offset:9216
    s_waitcnt lgkmcnt(0)
    s_waitcnt vmcnt(3)
    s_cmp_lg_u32 s96, 0
    s_cbranch_scc1 1
    s_waitcnt vmcnt(2)
    buffer_load_dwordx4 v[40:43], v2, s[12:15], s60 offen nt
    s_add_u32 s60, s60, 0x2000
    v_mul_u32_u24 v56, 3584, v3
    v_lshlrev_b32 v57, 4, v1
    v_cmp_gt_u32 vcc, 56, v1
    v_mov_b32 v58, 0x40000000
    s_nop 0
    v_cndmask_b32 v57, v58, v57, vcc
    v_lshl_add_u32 v58, v56, 1, v57
    v_add_u32 v59, 3584, v58
    v_add_u32 v57, v56, v57
    buffer_load_dwordx4 v[232:235], v57, s[32:35], 0 offen offset:0
    buffer_load_dwordx4 v[236:239], v57, s[32:35], 0 offen offset:896
    buffer_load_dwordx4 v[240:243], v57, s[32:35], 0 offen offset:1792
    buffer_load_dwordx4 v[244:247], v57, s[32:35], 0 offen offset:2688
    s_waitcnt vmcnt(7)
    s_cmp_lg_u32 s96, 0
    s_cbranch_scc1 1
    s_waitcnt vmcnt(6)
    buffer_load_dwordx4 v[44:47], v2, s[12:15], s60 offen nt
    s_add_u32 s60, s60, 0x2000
    s_waitcnt vmcnt(8)
    v_perm_b32 v80, v28, v24, s64
    v_perm_b32 v81, v28, v24, s65
    v_perm_b32 v82, v29, v25, s64
    v_perm_b32 v83, v29, v25, s65
    v_perm_b32 v84, v30, v26, s64
    v_perm_b32 v85, v30, v26, s65
    v_perm_b32 v86, v31, v27, s64
    v_perm_b32 v87, v31, v27, s65
    v_dot2_f32_bf16 v64, v80, v96, 0
    v_dot2_f32_bf16 v72, v80, v112, 0
    v_dot2_f32_bf16 v65, v81, v96, 0
    v_dot2_f32_bf16 v73, v81, v112, 0
    v_dot2_f32_bf16 v66, v82, v96, 0
    v_dot2_f32_bf16 v74, v82, v112, 0
    v_dot2_f32_bf16 v67, v83, v96, 0
    v_dot2_f32_bf16 v75, v83, v112, 0
    v_dot2_f32_bf16 v68, v84, v96, 0
    v_dot2_f32_bf16 v76, v84, v112, 0
    v_dot2_f32_bf16 v69, v85, v96, 0
    v_dot2_f32_bf16 v77, v85, v112, 0
    v_dot2_f32_bf16 v70, v86, v96, 0
    v_dot2_f32_bf16 v78, v86, v112, 0
    v_dot2_f32_bf16 v71, v87, v96, 0
    v_dot2_f32_bf16 v79, v87, v112, 0
    buffer_load_dwordx4 v[200:203], v58, s[20:23], 0 offen offset:0
    buffer_load_dwordx4 v[204:207], v58, s[20:23], 0 offen offset:896
    s_waitcnt vmcnt(9)
    s_cmp_lg_u32 s96, 0
    s_cbranch_scc1 1
    s_waitcnt vmcnt(8)
    buffer_load_dwordx4 v[48:51], v2, s[12:15], s60 offen nt
    s_add_u32 s60, s60, 0x2000
    s_cmp_lg_u32 s52, 5
    s_cbranch_scc1 L_ml
    v_lshlrev_b32 v13, 3, v19
    v_lshl_add_u32 v13, v23, 6, v13
    s_mov_b32 s61, 100000
L_m1:
    s_nop 4
    ds_read_b64 v[92:93], v13 offset:9216
    s_waitcnt lgkmcnt(0)
    v_cmp_eq_u32 vcc, -1, v93
    s_cbranch_vccz L_m1d
    s_sub_u32 s61, s61, 1
    s_cbranch_scc0 L_m1
L_m1d:
    s_nop 4
    v_mov_b32 v88, v92
    s_nop 1
    v_max_f32_dpp v88, v88, v88 quad_perm:[1,0,3,2] row_mask:0xf bank_mask:0xf
    s_nop 1
    v_max_f32_dpp v88, v88, v88 quad_perm:[2,3,0,1] row_mask:0xf bank_mask:0xf
    s_nop 1
    v_max_f32_dpp v88, v88, v88 row_half_mirror row_mask:0xf bank_mask:0xf
    v_sub_f32 v92, v92, v88
    v_mul_f32 v92, s66, v92
    v_exp_f32 v92, v92
    s_nop 0
    v_mul_f32 v89, v92, v93
    s_nop 1
    v_add_f32_dpp v89, v89, v89 quad_perm:[1,0,3,2] row_mask:0xf bank_mask:0xf
    s_nop 1
    v_add_f32_dpp v89, v89, v89 quad_perm:[2,3,0,1] row_mask:0xf bank_mask:0xf
    s_nop 1
    v_add_f32_dpp v89, v89, v89 row_half_mirror row_mask:0xf bank_mask:0xf
    v_lshlrev_b32 v13, 4, v23
    v_mov_b32 v90, v4
    v_mov_b32 v91, v4
    s_mov_b32 exec_lo, 1
    s_mov_b32 exec_hi, 1
    buffer_store_dwordx4 v[88:91], v13, s[48:51], s62 offen offset:2048 sc1
    s_mov_b64 exec, -1
L_ml:
    s_nop 4
    s_waitcnt vmcnt(9)
    s_cmp_lg_u32 s96, 0
    s_cbranch_scc1 1
    s_waitcnt vmcnt(8)
    buffer_load_dwordx4 v[52:55], v2, s[12:15], s60 offen nt
    s_add_u32 s60, s60, 0x2000
    s_waitcnt vmcnt(10)
    v_perm_b32 v80, v36, v32, s64
    v_perm_b32 v81, v36, v32, s65
    v_perm_b32 v82, v37, v33, s64
    v_perm_b32 v83, v37, v33, s65
    v_perm_b32 v84, v38, v34, s64
    v_perm_b32 v85, v38, v34, s65
    v_perm_b32 v86, v39, v35, s64
    v_perm_b32 v87, v39, v35, s65
    v_dot2_f32_bf16 v64, v80, v97, v64
    v_dot2_f32_bf16 v72, v80, v113, v72
    v_dot2_f32_bf16 v65, v81, v97, v65
    v_dot2_f32_bf16 v73, v81, v113, v73
    v_dot2_f32_bf16 v66, v82, v97, v66
    v_dot2_f32_bf16 v74, v82, v113, v74
    v_dot2_f32_bf16 v67, v83, v97, v67
    v_dot2_f32_bf16 v75, v83, v113, v75
    v_dot2_f32_bf16 v68, v84, v97, v68
    v_dot2_f32_bf16 v76, v84, v113, v76
    v_dot2_f32_bf16 v69, v85, v97, v69
    v_dot2_f32_bf16 v77, v85, v113, v77
    v_dot2_f32_bf16 v70, v86, v97, v70
    v_dot2_f32_bf16 v78, v86, v113, v78
    v_dot2_f32_bf16 v71, v87, v97, v71
    v_dot2_f32_bf16 v79, v87, v113, v79
    buffer_load_dwordx4 v[208:211], v58, s[20:23], 0 offen offset:1792
    buffer_load_dwordx4 v[212:215], v58, s[20:23], 0 offen offset:2688
    s_waitcnt vmcnt(11)
    s_cmp_lg_u32 s96, 0
    s_cbranch_scc1 1
    s_waitcnt vmcnt(6)
    buffer_load_dwordx4 v[128:131], v2, s[12:15], s60 offen nt
    s_add_u32 s60, s60, 0x2000
    s_waitcnt vmcnt(7)
    s_cmp_lg_u32 s96, 0
    s_cbranch_scc1 1
    s_waitcnt vmcnt(4)
    buffer_load_dwordx4 v[132:135], v2, s[12:15], s60 offen nt
    s_add_u32 s60, s60, 0x2000
    s_waitcnt vmcnt(8)
    v_perm_b32 v80, v44, v40, s64
    v_perm_b32 v81, v44, v40, s65
    v_perm_b32 v82, v45, v41, s64
    v_perm_b32 v83, v45, v41, s65
    v_perm_b32 v84, v46, v42, s64
    v_perm_b32 v85, v46, v42, s65
    v_perm_b32 v86, v47, v43, s64
    v_perm_b32 v87, v47, v43, s65
    v_dot2_f32_bf16 v64, v80, v98, v64
    v_dot2_f32_bf16 v72, v80, v114, v72
    v_dot2_f32_bf16 v65, v81, v98, v65
    v_dot2_f32_bf16 v73, v81, v114, v73
    v_dot2_f32_bf16 v66, v82, v98, v66
    v_dot2_f32_bf16 v74, v82, v114, v74
    v_dot2_f32_bf16 v67, v83, v98, v67
    v_dot2_f32_bf16 v75, v83, v114, v75
    v_dot2_f32_bf16 v68, v84, v98, v68
    v_dot2_f32_bf16 v76, v84, v114, v76
    v_dot2_f32_bf16 v69, v85, v98, v69
    v_dot2_f32_bf16 v77, v85, v114, v77
    v_dot2_f32_bf16 v70, v86, v98, v70
    v_dot2_f32_bf16 v78, v86, v114, v78
    v_dot2_f32_bf16 v71, v87, v98, v71
    v_dot2_f32_bf16 v79, v87, v114, v79
    buffer_load_dwordx4 v[216:219], v59, s[20:23], 0 offen offset:0
    buffer_load_dwordx4 v[220:223], v59, s[20:23], 0 offen offset:896
    s_waitcnt vmcnt(7)
    s_cmp_lg_u32 s96, 0
    s_cbranch_scc1 1
    s_waitcnt vmcnt(6)
    buffer_load_dwordx4 v[136:139], v2, s[12:15], s60 offen nt
    s_add_u32 s60, s60, 0x2000
    s_waitcnt vmcnt(7)
    s_cmp_lg_u32 s96, 0
    s_cbranch_scc1 1
    s_waitcnt vmcnt(4)
    buffer_load_dwordx4 v[140:143], v2, s[12:15], s60 offen nt
    s_add_u32 s60, s60, 0x2000
    s_waitcnt vmcnt(8)
    v_perm_b32 v80, v52, v48, s64
    v_perm_b32 v81, v52, v48, s65
    v_perm_b32 v82, v53, v49, s64
    v_perm_b32 v83, v53, v49, s65
    v_perm_b32 v84, v54, v50, s64
    v_perm_b32 v85, v54, v50, s65
    v_perm_b32 v86, v55, v51, s64
    v_perm_b32 v87, v55, v51, s65
    v_dot2_f32_bf16 v64, v80, v99, v64
    v_dot2_f32_bf16 v72, v80, v115, v72
    v_dot2_f32_bf16 v65, v81, v99, v65
    v_dot2_f32_bf16 v73, v81, v115, v73
    v_dot2_f32_bf16 v66, v82, v99, v66
    v_dot2_f32_bf16 v74, v82, v115, v74
    v_dot2_f32_bf16 v67, v83, v99, v67
    v_dot2_f32_bf16 v75, v83, v115, v75
    v_dot2_f32_bf16 v68, v84, v99, v68
    v_dot2_f32_bf16 v76, v84, v115, v76
    v_dot2_f32_bf16 v69, v85, v99, v69
    v_dot2_f32_bf16 v77, v85, v115, v77
    v_dot2_f32_bf16 v70, v86, v99, v70
    v_dot2_f32_bf16 v78, v86, v115, v78
    v_dot2_f32_bf16 v71, v87, v99, v71
    v_dot2_f32_bf16 v79, v87, v115, v79
    buffer_load_dwordx4 v[224:227], v59, s[20:23], 0 offen offset:1792
    buffer_load_dwordx4 v[228:231], v59, s[20:23], 0 offen offset:2688
    s_waitcnt vmcnt(7)
    s_cmp_lg_u32 s96, 0
    s_cbranch_scc1 1
    s_waitcnt vmcnt(6)
    buffer_load_dwordx4 v[144:147], v2, s[12:15], s60 offen nt
    s_add_u32 s60, s60, 0x2000
    v_lshlrev_b32 v45, 4, v19
    v_lshl_add_u32 v45, v3, 7, v45
    ds_read_b128 v[24:27], v45 offset:7168
    s_waitcnt lgkmcnt(0)
    v_add_f32_dpp v24, v24, v24 quad_perm:[1,0,3,2] row_mask:0xf bank_mask:0xf
    v_add_f32_dpp v25, v25, v25 quad_perm:[1,0,3,2] row_mask:0xf bank_mask:0xf
    v_add_f32_dpp v26, v26, v26 quad_perm:[1,0,3,2] row_mask:0xf bank_mask:0xf
    v_add_f32_dpp v27, v27, v27 quad_perm:[1,0,3,2] row_mask:0xf bank_mask:0xf
    v_add_f32_dpp v24, v24, v24 quad_perm:[2,3,0,1] row_mask:0xf bank_mask:0xf
    v_add_f32_dpp v25, v25, v25 quad_perm:[2,3,0,1] row_mask:0xf bank_mask:0xf
    v_add_f32_dpp v26, v26, v26 quad_perm:[2,3,0,1] row_mask:0xf bank_mask:0xf
    v_add_f32_dpp v27, v27, v27 quad_perm:[2,3,0,1] row_mask:0xf bank_mask:0xf
    v_mov_b32_dpp v28, v24 row_half_mirror row_mask:0xf bank_mask:0xf
    v_mov_b32_dpp v29, v25 row_half_mirror row_mask:0xf bank_mask:0xf
    v_mov_b32_dpp v30, v26 row_half_mirror row_mask:0xf bank_mask:0xf
    v_mov_b32_dpp v31, v27 row_half_mirror row_mask:0xf bank_mask:0xf
    v_cvt_pk_bf16_f32 v24, v24, v24
    v_and_b32 v24, 0xffff0000, v24
    v_cvt_pk_bf16_f32 v25, v25, v25
    v_and_b32 v25, 0xffff0000, v25
    v_cvt_pk_bf16_f32 v26, v26, v26
    v_and_b32 v26, 0xffff0000, v26
    v_cvt_pk_bf16_f32 v27, v27, v27
    v_and_b32 v27, 0xffff0000, v27
    v_cvt_pk_bf16_f32 v28, v28, v28
    v_and_b32 v28, 0xffff0000, v28
    v_cvt_pk_bf16_f32 v29, v29, v29
    v_and_b32 v29, 0xffff0000, v29
    v_cvt_pk_bf16_f32 v30, v30, v30
    v_and_b32 v30, 0xffff0000, v30
    v_cvt_pk_bf16_f32 v31, v31, v31
    v_and_b32 v31, 0xffff0000, v31
    v_mul_f32 v32, 0xbfb8aa3b, v24
    v_mul_f32 v33, 0xbfb8aa3b, v25
    v_mul_f32 v34, 0xbfb8aa3b, v26
    v_mul_f32 v35, 0xbfb8aa3b, v27
    v_exp_f32 v32, v32
    v_exp_f32 v33, v33
    v_exp_f32 v34, v34
    v_exp_f32 v35, v35
    v_add_f32 v32, 1.0, v32
    v_add_f32 v33, 1.0, v33
    v_add_f32 v34, 1.0, v34
    v_add_f32 v35, 1.0, v35
    v_rcp_f32 v32, v32
    v_rcp_f32 v33, v33
    v_rcp_f32 v34, v34
    v_rcp_f32 v35, v35
    v_mul_f32 v24, v24, v32
    v_mul_f32 v25, v25, v33
    v_mul_f32 v26, v26, v34
    v_mul_f32 v27, v27, v35
    v_cvt_pk_bf16_f32 v24, v24, v24
    v_and_b32 v24, 0xffff0000, v24
    v_cvt_pk_bf16_f32 v25, v25, v25
    v_and_b32 v25, 0xffff0000, v25
    v_cvt_pk_bf16_f32 v26, v26, v26
    v_and_b32 v26, 0xffff0000, v26
    v_cvt_pk_bf16_f32 v27, v27, v27
    v_and_b32 v27, 0xffff0000, v27
    v_mul_f32 v24, v24, v28
    v_mul_f32 v25, v25, v29
    v_mul_f32 v26, v26, v30
    v_mul_f32 v27, v27, v31
    v_cvt_pk_bf16_f32 v24, v24, v25
    v_cvt_pk_bf16_f32 v25, v26, v27
    v_readlane_b32 s76, v24, 0
    v_readlane_b32 s77, v25, 0
    s_waitcnt vmcnt(16)
    v_perm_b32 v28, v236, v232, s64
    v_perm_b32 v29, v236, v232, s65
    v_perm_b32 v30, v237, v233, s64
    v_perm_b32 v31, v237, v233, s65
    v_perm_b32 v32, v238, v234, s64
    v_perm_b32 v33, v238, v234, s65
    v_perm_b32 v34, v239, v235, s64
    v_perm_b32 v35, v239, v235, s65
    v_dot2_f32_bf16 v48, v28, s76, 0
    v_dot2_f32_bf16 v49, v29, s76, 0
    v_dot2_f32_bf16 v50, v30, s76, 0
    v_dot2_f32_bf16 v51, v31, s76, 0
    v_dot2_f32_bf16 v52, v32, s76, 0
    v_dot2_f32_bf16 v53, v33, s76, 0
    v_dot2_f32_bf16 v54, v34, s76, 0
    v_dot2_f32_bf16 v55, v35, s76, 0
    v_perm_b32 v28, v244, v240, s64
    v_perm_b32 v29, v244, v240, s65
    v_perm_b32 v30, v245, v241, s64
    v_perm_b32 v31, v245, v241, s65
    v_perm_b32 v32, v246, v242, s64
    v_perm_b32 v33, v246, v242, s65
    v_perm_b32 v34, v247, v243, s64
    v_perm_b32 v35, v247, v243, s65
    v_dot2_f32_bf16 v48, v28, s77, v48
    v_dot2_f32_bf16 v49, v29, s77, v49
    v_dot2_f32_bf16 v50, v30, s77, v50
    v_dot2_f32_bf16 v51, v31, s77, v51
    v_dot2_f32_bf16 v52, v32, s77, v52
    v_dot2_f32_bf16 v53, v33, s77, v53
    v_dot2_f32_bf16 v54, v34, s77, v54
    v_dot2_f32_bf16 v55, v35, s77, v55
    s_waitcnt vmcnt(7)
    s_cmp_lg_u32 s96, 0
    s_cbranch_scc1 1
    s_waitcnt vmcnt(4)
    buffer_load_dwordx4 v[148:151], v2, s[12:15], s60 offen nt
    s_add_u32 s60, s60, 0x2000
    s_waitcnt vmcnt(8)
    v_perm_b32 v80, v132, v128, s64
    v_perm_b32 v81, v132, v128, s65
    v_perm_b32 v82, v133, v129, s64
    v_perm_b32 v83, v133, v129, s65
    v_perm_b32 v84, v134, v130, s64
    v_perm_b32 v85, v134, v130, s65
    v_perm_b32 v86, v135, v131, s64
    v_perm_b32 v87, v135, v131, s65
    v_dot2_f32_bf16 v64, v80, v100, v64
    v_dot2_f32_bf16 v72, v80, v116, v72
    v_dot2_f32_bf16 v65, v81, v100, v65
    v_dot2_f32_bf16 v73, v81, v116, v73
    v_dot2_f32_bf16 v66, v82, v100, v66
    v_dot2_f32_bf16 v74, v82, v116, v74
    v_dot2_f32_bf16 v67, v83, v100, v67
    v_dot2_f32_bf16 v75, v83, v116, v75
    v_dot2_f32_bf16 v68, v84, v100, v68
    v_dot2_f32_bf16 v76, v84, v116, v76
    v_dot2_f32_bf16 v69, v85, v100, v69
    v_dot2_f32_bf16 v77, v85, v116, v77
    v_dot2_f32_bf16 v70, v86, v100, v70
    v_dot2_f32_bf16 v78, v86, v116, v78
    v_dot2_f32_bf16 v71, v87, v100, v71
    v_dot2_f32_bf16 v79, v87, v116, v79
    s_waitcnt vmcnt(5)
    s_cmp_lg_u32 s96, 0
    s_cbranch_scc1 1
    s_waitcnt vmcnt(4)
    buffer_load_dwordx4 v[152:155], v2, s[12:15], s60 offen nt
    s_add_u32 s60, s60, 0x2000
    s_waitcnt vmcnt(5)
    s_cmp_lg_u32 s96, 0
    s_cbranch_scc1 1
    s_waitcnt vmcnt(2)
    buffer_load_dwordx4 v[156:159], v2, s[12:15], s60 offen nt
    s_add_u32 s60, s60, 0x2000
    s_waitcnt vmcnt(6)
    v_perm_b32 v80, v140, v136, s64
    v_perm_b32 v81, v140, v136, s65
    v_perm_b32 v82, v141, v137, s64
    v_perm_b32 v83, v141, v137, s65
    v_perm_b32 v84, v142, v138, s64
    v_perm_b32 v85, v142, v138, s65
    v_perm_b32 v86, v143, v139, s64
    v_perm_b32 v87, v143, v139, s65
    v_dot2_f32_bf16 v64, v80, v101, v64
    v_dot2_f32_bf16 v72, v80, v117, v72
    v_dot2_f32_bf16 v65, v81, v101, v65
    v_dot2_f32_bf16 v73, v81, v117, v73
    v_dot2_f32_bf16 v66, v82, v101, v66
    v_dot2_f32_bf16 v74, v82, v117, v74
    v_dot2_f32_bf16 v67, v83, v101, v67
    v_dot2_f32_bf16 v75, v83, v117, v75
    v_dot2_f32_bf16 v68, v84, v101, v68
    v_dot2_f32_bf16 v76, v84, v117, v76
    v_dot2_f32_bf16 v69, v85, v101, v69
    v_dot2_f32_bf16 v77, v85, v117, v77
    v_dot2_f32_bf16 v70, v86, v101, v70
    v_dot2_f32_bf16 v78, v86, v117, v78
    v_dot2_f32_bf16 v71, v87, v101, v71
    v_dot2_f32_bf16 v79, v87, v117, v79
    s_waitcnt vmcnt(3)
    s_cmp_lg_u32 s96, 0
    s_cbranch_scc1 1
    s_waitcnt vmcnt(2)
    buffer_load_dwordx4 v[160:163], v2, s[12:15], s60 offen nt
    s_add_u32 s60, s60, 0x2000
    s_waitcnt vmcnt(5)
    v_perm_b32 v192, v204, v200, s64
    v_perm_b32 v193, v204, v200, s65
    v_perm_b32 v194, v205, v201, s64
    v_perm_b32 v195, v205, v201, s65
    v_perm_b32 v196, v206, v202, s64
    v_perm_b32 v197, v206, v202, s65
    v_perm_b32 v198, v207, v203, s64
    v_perm_b32 v199, v207, v203, s65
    v_perm_b32 v200, v212, v208, s64
    v_perm_b32 v201, v212, v208, s65
    v_perm_b32 v202, v213, v209, s64
    v_perm_b32 v203, v213, v209, s65
    v_perm_b32 v204, v214, v210, s64
    v_perm_b32 v205, v214, v210, s65
    v_perm_b32 v206, v215, v211, s64
    v_perm_b32 v207, v215, v211, s65
    v_perm_b32 v208, v220, v216, s64
    v_perm_b32 v209, v220, v216, s65
    v_perm_b32 v210, v221, v217, s64
    v_perm_b32 v211, v221, v217, s65
    v_perm_b32 v212, v222, v218, s64
    v_perm_b32 v213, v222, v218, s65
    v_perm_b32 v214, v223, v219, s64
    v_perm_b32 v215, v223, v219, s65
    v_perm_b32 v216, v228, v224, s64
    v_perm_b32 v217, v228, v224, s65
    v_perm_b32 v218, v229, v225, s64
    v_perm_b32 v219, v229, v225, s65
    v_perm_b32 v220, v230, v226, s64
    v_perm_b32 v221, v230, v226, s65
    v_perm_b32 v222, v231, v227, s64
    v_perm_b32 v223, v231, v227, s65
    s_waitcnt vmcnt(3)
    s_cmp_lg_u32 s96, 0
    s_cbranch_scc1 1
    s_waitcnt vmcnt(2)
    buffer_load_dwordx4 v[164:167], v2, s[12:15], s60 offen nt
    s_add_u32 s60, s60, 0x2000
    s_waitcnt vmcnt(4)
    v_perm_b32 v80, v148, v144, s64
    v_perm_b32 v81, v148, v144, s65
    v_perm_b32 v82, v149, v145, s64
    v_perm_b32 v83, v149, v145, s65
    v_perm_b32 v84, v150, v146, s64
    v_perm_b32 v85, v150, v146, s65
    v_perm_b32 v86, v151, v147, s64
    v_perm_b32 v87, v151, v147, s65
    v_dot2_f32_bf16 v64, v80, v102, v64
    v_dot2_f32_bf16 v72, v80, v118, v72
    v_dot2_f32_bf16 v65, v81, v102, v65
    v_dot2_f32_bf16 v73, v81, v118, v73
    v_dot2_f32_bf16 v66, v82, v102, v66
    v_dot2_f32_bf16 v74, v82, v118, v74
    v_dot2_f32_bf16 v67, v83, v102, v67
    v_dot2_f32_bf16 v75, v83, v118, v75
    v_dot2_f32_bf16 v68, v84, v102, v68
    v_dot2_f32_bf16 v76, v84, v118, v76
    v_dot2_f32_bf16 v69, v85, v102, v69
    v_dot2_f32_bf16 v77, v85, v118, v77
    v_dot2_f32_bf16 v70, v86, v102, v70
    v_dot2_f32_bf16 v78, v86, v118, v78
    v_dot2_f32_bf16 v71, v87, v102, v71
    v_dot2_f32_bf16 v79, v87, v118, v79
    s_waitcnt vmcnt(3)
    s_cmp_lg_u32 s96, 0
    s_cbranch_scc1 1
    s_waitcnt vmcnt(2)
    buffer_load_dwordx4 v[168:171], v2, s[12:15], s60 offen nt
    s_add_u32 s60, s60, 0x2000
    s_waitcnt vmcnt(3)
    s_cmp_lg_u32 s96, 0
    s_cbranch_scc1 1
    s_waitcnt vmcnt(2)
    buffer_load_dwordx4 v[172:175], v2, s[12:15], s60 offen nt
    s_add_u32 s60, s60, 0x2000
    s_waitcnt vmcnt(4)
    v_perm_b32 v80, v156, v152, s64
    v_perm_b32 v81, v156, v152, s65
    v_perm_b32 v82, v157, v153, s64
    v_perm_b32 v83, v157, v153, s65
    v_perm_b32 v84, v158, v154, s64
    v_perm_b32 v85, v158, v154, s65
    v_perm_b32 v86, v159, v155, s64
    v_perm_b32 v87, v159, v155, s65
    v_dot2_f32_bf16 v64, v80, v103, v64
    v_dot2_f32_bf16 v72, v80, v119, v72
    v_dot2_f32_bf16 v65, v81, v103, v65
    v_dot2_f32_bf16 v73, v81, v119, v73
    v_dot2_f32_bf16 v66, v82, v103, v66
    v_dot2_f32_bf16 v74, v82, v119, v74
    v_dot2_f32_bf16 v67, v83, v103, v67
    v_dot2_f32_bf16 v75, v83, v119, v75
    v_dot2_f32_bf16 v68, v84, v103, v68
    v_dot2_f32_bf16 v76, v84, v119, v76
    v_dot2_f32_bf16 v69, v85, v103, v69
    v_dot2_f32_bf16 v77, v85, v119, v77
    v_dot2_f32_bf16 v70, v86, v103, v70
    v_dot2_f32_bf16 v78, v86, v119, v78
    v_dot2_f32_bf16 v71, v87, v103, v71
    v_dot2_f32_bf16 v79, v87, v119, v79
    s_waitcnt vmcnt(3)
    s_cmp_lg_u32 s96, 0
    s_cbranch_scc1 1
    s_waitcnt vmcnt(2)
    buffer_load_dwordx4 v[176:179], v2, s[12:15], s60 offen nt
    s_add_u32 s60, s60, 0x2000
    s_waitcnt vmcnt(3)
    s_cmp_lg_u32 s96, 0
    s_cbranch_scc1 1
    s_waitcnt vmcnt(2)
    buffer_load_dwordx4 v[180:183], v2, s[12:15], s60 offen nt
    s_add_u32 s60, s60, 0x2000
    s_waitcnt vmcnt(4)
    v_perm_b32 v80, v164, v160, s64
    v_perm_b32 v81, v164, v160, s65
    v_perm_b32 v82, v165, v161, s64
    v_perm_b32 v83, v165, v161, s65
    v_perm_b32 v84, v166, v162, s64
    v_perm_b32 v85, v166, v162, s65
    v_perm_b32 v86, v167, v163, s64
    v_perm_b32 v87, v167, v163, s65
    v_dot2_f32_bf16 v64, v80, v104, v64
    v_dot2_f32_bf16 v72, v80, v120, v72
    v_dot2_f32_bf16 v65, v81, v104, v65
    v_dot2_f32_bf16 v73, v81, v120, v73
    v_dot2_f32_bf16 v66, v82, v104, v66
    v_dot2_f32_bf16 v74, v82, v120, v74
    v_dot2_f32_bf16 v67, v83, v104, v67
    v_dot2_f32_bf16 v75, v83, v120, v75
    v_dot2_f32_bf16 v68, v84, v104, v68
    v_dot2_f32_bf16 v76, v84, v120, v76
    v_dot2_f32_bf16 v69, v85, v104, v69
    v_dot2_f32_bf16 v77, v85, v120, v77
    v_dot2_f32_bf16 v70, v86, v104, v70
    v_dot2_f32_bf16 v78, v86, v120, v78
    v_dot2_f32_bf16 v71, v87, v104, v71
    v_dot2_f32_bf16 v79, v87, v120, v79
    s_waitcnt vmcnt(3)
    s_cmp_lg_u32 s96, 0
    s_cbranch_scc1 1
    s_waitcnt vmcnt(2)
    buffer_load_dwordx4 v[184:187], v2, s[12:15], s60 offen nt
    s_add_u32 s60, s60, 0x2000
    s_waitcnt vmcnt(3)
    s_cmp_lg_u32 s96, 0
    s_cbranch_scc1 1
    s_waitcnt vmcnt(2)
    buffer_load_dwordx4 v[188:191], v2, s[12:15], s60 offen nt
    s_add_u32 s60, s60, 0x2000
    s_waitcnt vmcnt(4)
    v_perm_b32 v80, v172, v168, s64
    v_perm_b32 v81, v172, v168, s65
    v_perm_b32 v82, v173, v169, s64
    v_perm_b32 v83, v173, v169, s65
    v_perm_b32 v84, v174, v170, s64
    v_perm_b32 v85, v174, v170, s65
    v_perm_b32 v86, v175, v171, s64
    v_perm_b32 v87, v175, v171, s65
    v_dot2_f32_bf16 v64, v80, v105, v64
    v_dot2_f32_bf16 v72, v80, v121, v72
    v_dot2_f32_bf16 v65, v81, v105, v65
    v_dot2_f32_bf16 v73, v81, v121, v73
    v_dot2_f32_bf16 v66, v82, v105, v66
    v_dot2_f32_bf16 v74, v82, v121, v74
    v_dot2_f32_bf16 v67, v83, v105, v67
    v_dot2_f32_bf16 v75, v83, v121, v75
    v_dot2_f32_bf16 v68, v84, v105, v68
    v_dot2_f32_bf16 v76, v84, v121, v76
    v_dot2_f32_bf16 v69, v85, v105, v69
    v_dot2_f32_bf16 v77, v85, v121, v77
    v_dot2_f32_bf16 v70, v86, v105, v70
    v_dot2_f32_bf16 v78, v86, v121, v78
    v_dot2_f32_bf16 v71, v87, v105, v71
    v_dot2_f32_bf16 v79, v87, v121, v79
    s_waitcnt vmcnt(3)
    buffer_load_dwordx4 v[128:131], v2, s[12:15], s60 offen nt
    s_add_u32 s60, s60, 0x2000
    s_waitcnt vmcnt(4)
    buffer_load_dwordx4 v[132:135], v2, s[12:15], s60 offen nt
    s_add_u32 s60, s60, 0x2000
    s_waitcnt vmcnt(5)
    buffer_load_dwordx4 v[136:139], v2, s[12:15], s60 offen nt
    s_add_u32 s60, s60, 0x2000
    s_lshl_b32 s67, s3, 15
    s_add_u32 s67, s67, 1048576
    s_lshr_b32 s5, s4, 2
    s_lshl_b32 s5, s5, 4
    v_lshl_add_u32 v40, v19, 12, s5
    buffer_load_dwordx3 v[24:26], v40, s[48:51], s67 offen offset:2048 sc1
    s_lshl_b32 s5, s4, 8
    v_lshlrev_b32 v27, 12, v19
    v_lshl_add_u32 v27, v16, 2, v27
    v_lshl_add_u32 v27, v3, 5, v27
    v_add_u32 v27, s5, v27
    v_cmp_eq_u32 vcc, s4, v19
    v_mov_b32 v36, 0x40000000
    s_nop 0
    v_cndmask_b32 v27, v27, v36, vcc
    v_and_b32 v36, 3, v16
    v_lshlrev_b32 v36, 3, v36
    v_lshrrev_b32 v41, v36, v4
    v_cndmask_b32 v41, v41, 0, vcc
    v_mul_u32_u24 v37, 2320, v19
    v_lshrrev_b32 v36, 2, v16
    v_mul_u32_u24 v36, 1152, v36
    v_add_u32 v37, v37, v36
    v_and_b32 v36, 3, v16
    v_lshl_add_u32 v37, v36, 2, v37
    v_lshl_add_u32 v37, v3, 4, v37
    s_lshl_b32 s5, s4, 7
    v_add_u32 v37, s5, v37
    v_mul_u32_u24 v28, 2320, v3
    v_lshl_add_u32 v28, v1, 4, v28
    v_and_b32 v29, 3, v1
    v_mul_u32_u24 v29, 4640, v29
    v_bfe_u32 v30, v1, 2, 1
    v_mul_u32_u24 v30, 1152, v30
    v_add_u32 v29, v29, v30
    v_lshl_add_u32 v29, v16, 4, v29
    v_lshl_add_u32 v29, v3, 7, v29
    v_lshlrev_b32 v30, 2, v0
    s_lshl_b32 s68, s53, 17
    s_add_u32 s68, s68, 524288
    s_lshl_b32 s5, s55, 7
    s_add_u32 s68, s68, s5
    v_lshlrev_b32 v31, 11, v19
    v_lshl_add_u32 v31, v16, 4, v31
    s_mul_i32 s5, s53, 896
    s_lshl_b32 s7, s55, 6
    s_add_u32 s5, s5, s7
    v_lshl_add_u32 v32, v16, 3, s5
    s_add_u32 s69, s68, 16384
    s_add_u32 s70, s68, 32768
    s_add_u32 s71, s68, 49152
    s_add_u32 s72, s68, 65536
    s_add_u32 s73, s68, 81920
    s_add_u32 s74, s68, 98304
    s_add_u32 s75, s68, 114688
    s_lshl_b32 s63, s53, 17
    s_add_u32 s63, s63, 524288
    s_mul_i32 s5, s55, 2304
    s_add_u32 s68, s63, s5
    s_lshl_b32 s5, s55, 5
    s_add_u32 s63, s63, s5
    v_lshlrev_b32 v31, 4, v1
    v_lshrrev_b32 v42, 3, v0
    v_mul_u32_u24 v42, 2304, v42
    v_bfe_u32 v36, v0, 2, 1
    v_lshl_add_u32 v42, v36, 4, v42
    s_mul_i32 s5, s53, 896
    s_lshl_b32 s7, s55, 4
    s_add_u32 s5, s5, s7
    v_and_b32 v36, 1, v1
    v_lshl_add_u32 v32, v36, 3, s5
    buffer_load_dwordx2 v[34:35], v32, s[36:39], 0 offen
    s_waitcnt vmcnt(8)
    buffer_load_dwordx4 v[140:143], v2, s[12:15], s60 offen nt
    s_add_u32 s60, s60, 0x2000
    s_waitcnt vmcnt(9)
    buffer_load_dwordx4 v[144:147], v2, s[12:15], s60 offen nt
    s_add_u32 s60, s60, 0x2000
    s_waitcnt vmcnt(9)
    buffer_load_dwordx4 v[148:151], v2, s[12:15], s60 offen nt
    s_add_u32 s60, s60, 0x2000
    s_waitcnt vmcnt(10)
    v_perm_b32 v80, v180, v176, s64
    v_perm_b32 v81, v180, v176, s65
    v_perm_b32 v82, v181, v177, s64
    v_perm_b32 v83, v181, v177, s65
    v_perm_b32 v84, v182, v178, s64
    v_perm_b32 v85, v182, v178, s65
    v_perm_b32 v86, v183, v179, s64
    v_perm_b32 v87, v183, v179, s65
    v_dot2_f32_bf16 v64, v80, v106, v64
    v_dot2_f32_bf16 v72, v80, v122, v72
    v_dot2_f32_bf16 v65, v81, v106, v65
    v_dot2_f32_bf16 v73, v81, v122, v73
    v_dot2_f32_bf16 v66, v82, v106, v66
    v_dot2_f32_bf16 v74, v82, v122, v74
    v_dot2_f32_bf16 v67, v83, v106, v67
    v_dot2_f32_bf16 v75, v83, v122, v75
    v_dot2_f32_bf16 v68, v84, v106, v68
    v_dot2_f32_bf16 v76, v84, v122, v76
    v_dot2_f32_bf16 v69, v85, v106, v69
    v_dot2_f32_bf16 v77, v85, v122, v77
    v_dot2_f32_bf16 v70, v86, v106, v70
    v_dot2_f32_bf16 v78, v86, v122, v78
    v_dot2_f32_bf16 v71, v87, v106, v71
    v_dot2_f32_bf16 v79, v87, v122, v79
    s_waitcnt vmcnt(9)
    buffer_load_dwordx4 v[152:155], v2, s[12:15], s60 offen nt
    s_add_u32 s60, s60, 0x2000
    s_waitcnt vmcnt(9)
    buffer_load_dwordx4 v[156:159], v2, s[12:15], s60 offen nt
    s_add_u32 s60, s60, 0x2000
    s_waitcnt vmcnt(10)
    v_perm_b32 v80, v188, v184, s64
    v_perm_b32 v81, v188, v184, s65
    v_perm_b32 v82, v189, v185, s64
    v_perm_b32 v83, v189, v185, s65
    v_perm_b32 v84, v190, v186, s64
    v_perm_b32 v85, v190, v186, s65
    v_perm_b32 v86, v191, v187, s64
    v_perm_b32 v87, v191, v187, s65
    v_dot2_f32_bf16 v64, v80, v107, v64
    v_dot2_f32_bf16 v72, v80, v123, v72
    v_dot2_f32_bf16 v65, v81, v107, v65
    v_dot2_f32_bf16 v73, v81, v123, v73
    v_dot2_f32_bf16 v66, v82, v107, v66
    v_dot2_f32_bf16 v74, v82, v123, v74
    v_dot2_f32_bf16 v67, v83, v107, v67
    v_dot2_f32_bf16 v75, v83, v123, v75
    v_dot2_f32_bf16 v68, v84, v107, v68
    v_dot2_f32_bf16 v76, v84, v123, v76
    v_dot2_f32_bf16 v69, v85, v107, v69
    v_dot2_f32_bf16 v77, v85, v123, v77
    v_dot2_f32_bf16 v70, v86, v107, v70
    v_dot2_f32_bf16 v78, v86, v123, v78
    v_dot2_f32_bf16 v71, v87, v107, v71
    v_dot2_f32_bf16 v79, v87, v123, v79
    v_lshlrev_b32 v13, 3, v19
    v_lshl_add_u32 v13, v23, 6, v13
    s_mov_b32 s61, 100000
L_m2:
    s_nop 4
    ds_read_b64 v[92:93], v13 offset:9216
    s_waitcnt lgkmcnt(0)
    v_cmp_eq_u32 vcc, -1, v93
    s_cbranch_vccz L_m2d
    s_sub_u32 s61, s61, 1
    s_cbranch_scc0 L_m2
L_m2d:
    s_nop 4
    v_mov_b32 v88, v92
    s_nop 1
    v_max_f32_dpp v88, v88, v88 quad_perm:[1,0,3,2] row_mask:0xf bank_mask:0xf
    s_nop 1
    v_max_f32_dpp v88, v88, v88 quad_perm:[2,3,0,1] row_mask:0xf bank_mask:0xf
    s_nop 1
    v_max_f32_dpp v88, v88, v88 row_half_mirror row_mask:0xf bank_mask:0xf
    v_sub_f32 v90, v10, v88
    v_mul_f32 v90, s66, v90
    v_exp_f32 v90, v90
    s_nop 0
    v_mov_b32 v91, v90
    s_waitcnt vmcnt(8)
    v_perm_b32 v80, v132, v128, s64
    v_perm_b32 v81, v132, v128, s65
    v_perm_b32 v82, v133, v129, s64
    v_perm_b32 v83, v133, v129, s65
    v_perm_b32 v84, v134, v130, s64
    v_perm_b32 v85, v134, v130, s65
    v_perm_b32 v86, v135, v131, s64
    v_perm_b32 v87, v135, v131, s65
    v_dot2_f32_bf16 v64, v80, v108, v64
    v_dot2_f32_bf16 v72, v80, v124, v72
    v_dot2_f32_bf16 v65, v81, v108, v65
    v_dot2_f32_bf16 v73, v81, v124, v73
    v_dot2_f32_bf16 v66, v82, v108, v66
    v_dot2_f32_bf16 v74, v82, v124, v74
    v_dot2_f32_bf16 v67, v83, v108, v67
    v_dot2_f32_bf16 v75, v83, v124, v75
    v_dot2_f32_bf16 v68, v84, v108, v68
    v_dot2_f32_bf16 v76, v84, v124, v76
    v_dot2_f32_bf16 v69, v85, v108, v69
    v_dot2_f32_bf16 v77, v85, v124, v77
    v_dot2_f32_bf16 v70, v86, v108, v70
    v_dot2_f32_bf16 v78, v86, v124, v78
    v_dot2_f32_bf16 v71, v87, v108, v71
    v_dot2_f32_bf16 v79, v87, v124, v79
    s_waitcnt vmcnt(4)
    v_perm_b32 v80, v140, v136, s64
    v_perm_b32 v81, v140, v136, s65
    v_perm_b32 v82, v141, v137, s64
    v_perm_b32 v83, v141, v137, s65
    v_perm_b32 v84, v142, v138, s64
    v_perm_b32 v85, v142, v138, s65
    v_perm_b32 v86, v143, v139, s64
    v_perm_b32 v87, v143, v139, s65
    v_dot2_f32_bf16 v64, v80, v109, v64
    v_dot2_f32_bf16 v72, v80, v125, v72
    v_dot2_f32_bf16 v65, v81, v109, v65
    v_dot2_f32_bf16 v73, v81, v125, v73
    v_dot2_f32_bf16 v66, v82, v109, v66
    v_dot2_f32_bf16 v74, v82, v125, v74
    v_dot2_f32_bf16 v67, v83, v109, v67
    v_dot2_f32_bf16 v75, v83, v125, v75
    v_dot2_f32_bf16 v68, v84, v109, v68
    v_dot2_f32_bf16 v76, v84, v125, v76
    v_dot2_f32_bf16 v69, v85, v109, v69
    v_dot2_f32_bf16 v77, v85, v125, v77
    v_dot2_f32_bf16 v70, v86, v109, v70
    v_dot2_f32_bf16 v78, v86, v125, v78
    v_dot2_f32_bf16 v71, v87, v109, v71
    v_dot2_f32_bf16 v79, v87, v125, v79
    s_waitcnt vmcnt(2)
    v_perm_b32 v80, v148, v144, s64
    v_perm_b32 v81, v148, v144, s65
    v_perm_b32 v82, v149, v145, s64
    v_perm_b32 v83, v149, v145, s65
    v_perm_b32 v84, v150, v146, s64
    v_perm_b32 v85, v150, v146, s65
    v_perm_b32 v86, v151, v147, s64
    v_perm_b32 v87, v151, v147, s65
    v_dot2_f32_bf16 v64, v80, v110, v64
    v_dot2_f32_bf16 v72, v80, v126, v72
    v_dot2_f32_bf16 v65, v81, v110, v65
    v_dot2_f32_bf16 v73, v81, v126, v73
    v_dot2_f32_bf16 v66, v82, v110, v66
    v_dot2_f32_bf16 v74, v82, v126, v74
    v_dot2_f32_bf16 v67, v83, v110, v67
    v_dot2_f32_bf16 v75, v83, v126, v75
    v_dot2_f32_bf16 v68, v84, v110, v68
    v_dot2_f32_bf16 v76, v84, v126, v76
    v_dot2_f32_bf16 v69, v85, v110, v69
    v_dot2_f32_bf16 v77, v85, v126, v77
    v_dot2_f32_bf16 v70, v86, v110, v70
    v_dot2_f32_bf16 v78, v86, v126, v78
    v_dot2_f32_bf16 v71, v87, v110, v71
    v_dot2_f32_bf16 v79, v87, v126, v79
    s_waitcnt vmcnt(0)
    v_perm_b32 v80, v156, v152, s64
    v_perm_b32 v81, v156, v152, s65
    v_perm_b32 v82, v157, v153, s64
    v_perm_b32 v83, v157, v153, s65
    v_perm_b32 v84, v158, v154, s64
    v_perm_b32 v85, v158, v154, s65
    v_perm_b32 v86, v159, v155, s64
    v_perm_b32 v87, v159, v155, s65
    v_dot2_f32_bf16 v64, v80, v111, v64
    v_dot2_f32_bf16 v72, v80, v127, v72
    v_dot2_f32_bf16 v65, v81, v111, v65
    v_dot2_f32_bf16 v73, v81, v127, v73
    v_dot2_f32_bf16 v66, v82, v111, v66
    v_dot2_f32_bf16 v74, v82, v127, v74
    v_dot2_f32_bf16 v67, v83, v111, v67
    v_dot2_f32_bf16 v75, v83, v127, v75
    v_dot2_f32_bf16 v68, v84, v111, v68
    v_dot2_f32_bf16 v76, v84, v127, v76
    v_dot2_f32_bf16 v69, v85, v111, v69
    v_dot2_f32_bf16 v77, v85, v127, v77
    v_dot2_f32_bf16 v70, v86, v111, v70
    v_dot2_f32_bf16 v78, v86, v127, v78
    v_dot2_f32_bf16 v71, v87, v111, v71
    v_dot2_f32_bf16 v79, v87, v127, v79
    v_permlane32_swap_b32 v64, v72
    v_permlane32_swap_b32 v65, v73
    v_permlane32_swap_b32 v66, v74
    v_permlane32_swap_b32 v67, v75
    v_permlane32_swap_b32 v68, v76
    v_permlane32_swap_b32 v69, v77
    v_permlane32_swap_b32 v70, v78
    v_permlane32_swap_b32 v71, v79
    v_pk_add_f32 v[64:65], v[64:65], v[72:73]
    v_pk_add_f32 v[66:67], v[66:67], v[74:75]
    v_pk_add_f32 v[68:69], v[68:69], v[76:77]
    v_pk_add_f32 v[70:71], v[70:71], v[78:79]
    v_pk_mul_f32 v[64:65], v[64:65], v[90:91]
    v_pk_mul_f32 v[66:67], v[66:67], v[90:91]
    v_pk_mul_f32 v[68:69], v[68:69], v[90:91]
    v_pk_mul_f32 v[70:71], v[70:71], v[90:91]
    ds_write_b128 v28, v[64:67] offset:12288
    ds_write_b128 v28, v[68:71] offset:13440
    buffer_load_dword v38, v27, s[48:51], s67 offen sc1
    s_waitcnt lgkmcnt(0)
    s_barrier
    ds_read_b128 v[80:83], v29 offset:12288
    ds_read_b128 v[84:87], v29 offset:14608
    ds_read_b32 v39, v37 offset:12288
    s_waitcnt lgkmcnt(1)
    v_pk_add_f32 v[80:81], v[80:81], v[84:85]
    v_pk_add_f32 v[82:83], v[82:83], v[86:87]
    s_nop 0
    v_add_f32_dpp v80, v80, v80 quad_perm:[1,0,3,2] row_mask:0xf bank_mask:0xf
    v_add_f32_dpp v81, v81, v81 quad_perm:[1,0,3,2] row_mask:0xf bank_mask:0xf
    v_add_f32_dpp v82, v82, v82 quad_perm:[1,0,3,2] row_mask:0xf bank_mask:0xf
    v_add_f32_dpp v83, v83, v83 quad_perm:[1,0,3,2] row_mask:0xf bank_mask:0xf
    v_add_f32_dpp v80, v80, v80 quad_perm:[2,3,0,1] row_mask:0xf bank_mask:0xf
    v_add_f32_dpp v81, v81, v81 quad_perm:[2,3,0,1] row_mask:0xf bank_mask:0xf
    v_add_f32_dpp v82, v82, v82 quad_perm:[2,3,0,1] row_mask:0xf bank_mask:0xf
    v_add_f32_dpp v83, v83, v83 quad_perm:[2,3,0,1] row_mask:0xf bank_mask:0xf
    v_perm_b32 v80, v80, v4, s28
    v_perm_b32 v81, v81, v4, s29
    v_perm_b32 v82, v82, v4, s30
    v_perm_b32 v83, v83, v4, s31
    s_mov_b32 exec_lo, 0x11111111
    s_mov_b32 exec_hi, 0x11111111
    buffer_store_dwordx4 v[80:83], v30, s[48:51], s62 offen sc1
    s_mov_b64 exec, -1
    s_waitcnt vmcnt(8)
    s_mov_b32 s61, 20000
L_mls_c:
    s_nop 4
    v_cmp_ne_u32 vcc, s101, v26
    s_cbranch_vccz L_mls_d
    s_sub_u32 s61, s61, 1
    s_cbranch_scc1 L_mls_d
    buffer_load_dwordx3 v[24:26], v40, s[48:51], s67 offen offset:2048 sc1
    s_waitcnt vmcnt(0)
    s_branch L_mls_c
L_mls_d:
    s_nop 4
    v_mov_b32 v36, v24
    s_nop 1
    v_max_f32_dpp v36, v36, v36 quad_perm:[1,0,3,2] row_mask:0xf bank_mask:0xf
    s_nop 1
    v_max_f32_dpp v36, v36, v36 quad_perm:[2,3,0,1] row_mask:0xf bank_mask:0xf
    s_nop 1
    v_max_f32_dpp v36, v36, v36 row_half_mirror row_mask:0xf bank_mask:0xf
    v_sub_f32 v24, v24, v36
    v_mul_f32 v24, s66, v24
    v_exp_f32 v24, v24
    s_nop 0
    v_mul_f32 v25, v24, v25
    s_nop 1
    v_add_f32_dpp v25, v25, v25 quad_perm:[1,0,3,2] row_mask:0xf bank_mask:0xf
    s_nop 1
    v_add_f32_dpp v25, v25, v25 quad_perm:[2,3,0,1] row_mask:0xf bank_mask:0xf
    s_nop 1
    v_add_f32_dpp v25, v25, v25 row_half_mirror row_mask:0xf bank_mask:0xf
    v_rcp_f32 v25, v25
    s_nop 0
    v_mul_f32 v33, v24, v25
    s_nop 0
    v_readlane_b32 s76, v33, s4
    s_waitcnt lgkmcnt(0)
    s_nop 0
    v_mul_f32 v24, s76, v39
    s_waitcnt vmcnt(1)
    s_mov_b32 s61, 20000
L_os_c:
    s_nop 4
    v_cmp_ne_u32_sdwa vcc, v38, v41 src0_sel:BYTE_0 src1_sel:BYTE_0
    s_cbranch_vccz L_os_d
    s_sub_u32 s61, s61, 1
    s_cbranch_scc1 L_os_d
    buffer_load_dword v38, v27, s[48:51], s67 offen sc1
    s_waitcnt vmcnt(0)
    s_branch L_os_c
L_os_d:
    s_nop 4
    v_and_b32 v38, 0xffffff00, v38
    v_fmac_f32 v24, v38, v33
    s_nop 1
    v_add_f32_dpp v24, v24, v24 quad_perm:[1,0,3,2] row_mask:0xf bank_mask:0xf
    s_nop 1
    v_add_f32_dpp v24, v24, v24 quad_perm:[2,3,0,1] row_mask:0xf bank_mask:0xf
    s_nop 1
    v_add_f32_dpp v24, v24, v24 row_half_mirror row_mask:0xf bank_mask:0xf
    s_nop 1
    v_mov_b32_dpp v25, v24 row_ror:8 row_mask:0xf bank_mask:0xf
    v_cvt_pk_bf16_f32 v24, v24, v25
    s_nop 0
    v_readlane_b32 s76, v24, 0
    v_readlane_b32 s77, v24, 16
    v_readlane_b32 s78, v24, 32
    v_readlane_b32 s79, v24, 48
    v_dot2_f32_bf16 v48, v192, s76, v48
    v_dot2_f32_bf16 v49, v193, s76, v49
    v_dot2_f32_bf16 v50, v194, s76, v50
    v_dot2_f32_bf16 v51, v195, s76, v51
    v_dot2_f32_bf16 v52, v196, s76, v52
    v_dot2_f32_bf16 v53, v197, s76, v53
    v_dot2_f32_bf16 v54, v198, s76, v54
    v_dot2_f32_bf16 v55, v199, s76, v55
    v_dot2_f32_bf16 v48, v200, s77, v48
    v_dot2_f32_bf16 v49, v201, s77, v49
    v_dot2_f32_bf16 v50, v202, s77, v50
    v_dot2_f32_bf16 v51, v203, s77, v51
    v_dot2_f32_bf16 v52, v204, s77, v52
    v_dot2_f32_bf16 v53, v205, s77, v53
    v_dot2_f32_bf16 v54, v206, s77, v54
    v_dot2_f32_bf16 v55, v207, s77, v55
    v_dot2_f32_bf16 v48, v208, s78, v48
    v_dot2_f32_bf16 v49, v209, s78, v49
    v_dot2_f32_bf16 v50, v210, s78, v50
    v_dot2_f32_bf16 v51, v211, s78, v51
    v_dot2_f32_bf16 v52, v212, s78, v52
    v_dot2_f32_bf16 v53, v213, s78, v53
    v_dot2_f32_bf16 v54, v214, s78, v54
    v_dot2_f32_bf16 v55, v215, s78, v55
    v_dot2_f32_bf16 v48, v216, s79, v48
    v_dot2_f32_bf16 v49, v217, s79, v49
    v_dot2_f32_bf16 v50, v218, s79, v50
    v_dot2_f32_bf16 v51, v219, s79, v51
    v_dot2_f32_bf16 v52, v220, s79, v52
    v_dot2_f32_bf16 v53, v221, s79, v53
    v_dot2_f32_bf16 v54, v222, s79, v54
    v_dot2_f32_bf16 v55, v223, s79, v55
    ds_write_b128 v28, v[48:51] offset:30848
    s_nop 1
    ds_write_b128 v28, v[52:55] offset:32000
    s_waitcnt lgkmcnt(0)
    s_barrier
    s_cmp_eq_u32 s52, 7
    s_cbranch_scc1 L_fin
    ds_read_b128 v[80:83], v29 offset:30848
    ds_read_b128 v[84:87], v29 offset:33168
    s_waitcnt lgkmcnt(0)
    v_pk_add_f32 v[80:81], v[80:81], v[84:85]
    v_pk_add_f32 v[82:83], v[82:83], v[86:87]
    s_nop 0
    v_add_f32_dpp v80, v80, v80 quad_perm:[1,0,3,2] row_mask:0xf bank_mask:0xf
    v_add_f32_dpp v81, v81, v81 quad_perm:[1,0,3,2] row_mask:0xf bank_mask:0xf
    v_add_f32_dpp v82, v82, v82 quad_perm:[1,0,3,2] row_mask:0xf bank_mask:0xf
    v_add_f32_dpp v83, v83, v83 quad_perm:[1,0,3,2] row_mask:0xf bank_mask:0xf
    v_add_f32_dpp v80, v80, v80 quad_perm:[2,3,0,1] row_mask:0xf bank_mask:0xf
    v_add_f32_dpp v81, v81, v81 quad_perm:[2,3,0,1] row_mask:0xf bank_mask:0xf
    v_add_f32_dpp v82, v82, v82 quad_perm:[2,3,0,1] row_mask:0xf bank_mask:0xf
    v_add_f32_dpp v83, v83, v83 quad_perm:[2,3,0,1] row_mask:0xf bank_mask:0xf
    v_perm_b32 v80, v80, v4, s28
    v_perm_b32 v81, v81, v4, s29
    v_perm_b32 v82, v82, v4, s30
    v_perm_b32 v83, v83, v4, s31
    s_mov_b32 exec_lo, 0x11111111
    s_mov_b32 exec_hi, 0x11111111
    buffer_store_dwordx4 v[80:83], v42, s[48:51], s63 offen sc1
    s_branch L_done
L_fin:
    s_nop 4
    s_cmp_ge_u32 s55, 56
    s_cbranch_scc1 L_done
    buffer_load_dwordx4 v[64:67], v31, s[48:51], s68 offen offset:0 sc1
    buffer_load_dwordx4 v[68:71], v31, s[48:51], s68 offen offset:1024 sc1
    s_waitcnt vmcnt(0)
    s_mov_b32 s61, 20000
L_fs_c:
    s_nop 4
    v_xor_b32 v64, s44, v64
    v_xor_b32 v65, s45, v65
    v_xor_b32 v66, s46, v66
    v_xor_b32 v67, s47, v67
    v_xor_b32 v68, s44, v68
    v_xor_b32 v69, s45, v69
    v_xor_b32 v70, s46, v70
    v_xor_b32 v71, s47, v71
    v_or_b32 v60, v64, v65
    v_or_b32 v61, v66, v67
    v_or_b32 v62, v68, v69
    v_or_b32 v63, v70, v71
    v_or3_b32 v60, v60, v61, v62
    v_or_b32 v60, v60, v63
    v_and_b32 v60, 0xff, v60
    v_cmp_ne_u32 vcc, 0, v60
    s_cbranch_vccz L_fs_d
    s_sub_u32 s61, s61, 1
    s_cbranch_scc1 L_fs_d
    buffer_load_dwordx4 v[64:67], v31, s[48:51], s68 offen offset:0 sc1
    buffer_load_dwordx4 v[68:71], v31, s[48:51], s68 offen offset:1024 sc1
    s_waitcnt vmcnt(0)
    s_branch L_fs_c
L_fs_d:
    s_nop 4
    v_pk_add_f32 v[64:65], v[64:65], v[68:69]
    v_pk_add_f32 v[66:67], v[66:67], v[70:71]
    v_lshlrev_b32 v36, 16, v34
    v_and_b32 v37, 0xffff0000, v34
    v_lshlrev_b32 v38, 16, v35
    v_and_b32 v39, 0xffff0000, v35
    v_add_f32_dpp v64, v64, v64 quad_perm:[2,3,0,1] row_mask:0xf bank_mask:0xf
    v_add_f32_dpp v65, v65, v65 quad_perm:[2,3,0,1] row_mask:0xf bank_mask:0xf
    v_add_f32_dpp v66, v66, v66 quad_perm:[2,3,0,1] row_mask:0xf bank_mask:0xf
    v_add_f32_dpp v67, v67, v67 quad_perm:[2,3,0,1] row_mask:0xf bank_mask:0xf
    v_add_f32_dpp v64, v64, v64 row_ror:4 row_mask:0xf bank_mask:0xf
    v_add_f32_dpp v65, v65, v65 row_ror:4 row_mask:0xf bank_mask:0xf
    v_add_f32_dpp v66, v66, v66 row_ror:4 row_mask:0xf bank_mask:0xf
    v_add_f32_dpp v67, v67, v67 row_ror:4 row_mask:0xf bank_mask:0xf
    v_add_f32_dpp v64, v64, v64 row_ror:8 row_mask:0xf bank_mask:0xf
    v_add_f32_dpp v65, v65, v65 row_ror:8 row_mask:0xf bank_mask:0xf
    v_add_f32_dpp v66, v66, v66 row_ror:8 row_mask:0xf bank_mask:0xf
    v_add_f32_dpp v67, v67, v67 row_ror:8 row_mask:0xf bank_mask:0xf
    v_mov_b32 v68, v64
    v_mov_b32 v69, v65
    v_mov_b32 v70, v66
    v_mov_b32 v71, v67
    v_permlane16_swap_b32 v64, v68
    v_permlane16_swap_b32 v65, v69
    v_permlane16_swap_b32 v66, v70
    v_permlane16_swap_b32 v67, v71
    v_pk_add_f32 v[64:65], v[64:65], v[68:69]
    v_pk_add_f32 v[66:67], v[66:67], v[70:71]
    v_mov_b32 v68, v64
    v_mov_b32 v69, v65
    v_mov_b32 v70, v66
    v_mov_b32 v71, v67
    v_permlane32_swap_b32 v64, v68
    v_permlane32_swap_b32 v65, v69
    v_permlane32_swap_b32 v66, v70
    v_permlane32_swap_b32 v67, v71
    v_pk_add_f32 v[64:65], v[64:65], v[68:69]
    v_pk_add_f32 v[66:67], v[66:67], v[70:71]
    v_pk_add_f32 v[64:65], v[64:65], v[36:37]
    v_pk_add_f32 v[66:67], v[66:67], v[38:39]
    v_cvt_pk_bf16_f32 v64, v64, v65
    v_cvt_pk_bf16_f32 v65, v66, v67
    s_mov_b64 exec, 3
    buffer_store_dwordx2 v[64:65], v32, s[40:43], 0 offen
    s_cmp_lg_u32 s2, 0
    s_cbranch_scc1 L_done
    s_mov_b64 exec, 1
    s_mov_b32 s5, 269824
    buffer_store_dword v4, off, s[48:51], s5 sc1
L_done:
    s_nop 4
L_end:
    s_nop 4
s_endpgm
.section .rodata,"a"
.p2align 6
.amdhsa_kernel parallel_sum__sliding_block_cached__swiglu_ffn__decode_kernel
  .amdhsa_next_free_vgpr 256
  .amdhsa_next_free_sgpr 102
  .amdhsa_accum_offset 256
  .amdhsa_group_segment_fixed_size 0
  .amdhsa_kernarg_size 96
  .amdhsa_user_sgpr_count 2
  .amdhsa_user_sgpr_kernarg_segment_ptr 1
  .amdhsa_system_sgpr_workgroup_id_x 1
.end_amdhsa_kernel
```
